```python
import torch

def _softmax(x, axis=-1):
    return torch.softmax(x, dim=axis)
def _gelu(x):
    return torch.nn.functional.gelu(x, approximate="tanh")
def _silu(x):
    return torch.nn.functional.silu(x)
def _sigmoid(x):
    return torch.sigmoid(x)
def _layernorm(x, axis=-1, eps=1e-5):
    m = x.mean(dim=axis, keepdim=True)
    v = x.var(dim=axis, keepdim=True, unbiased=False)
    return (x - m) / torch.sqrt(v + eps)
def _scatter_add(tgt, idx, src, axis=0):
    return tgt.clone().index_add_(axis, idx, src)
def _segment_sum(src, seg, n):
    out = torch.zeros((n,) + src.shape[1:], dtype=src.dtype)
    return out.index_add_(0, seg, src)
def _pad(x, pw):
    flat = tuple(v for pair in reversed(pw) for v in pair)
    return torch.nn.functional.pad(x, flat)

kernel_name = 'standalone__gqa_softmax__sampling'

def setup_inputs():

    _w = (lambda a: (lambda t: t.to(torch.bfloat16) if t.is_floating_point() else t)(torch.as_tensor(a)))
    B, Hq, Hkv, Sq, Sk, D = 8, 32, 8, 32, 8192, 128
    return {
        "q": _w((lambda *s: torch.randn(*s, dtype=torch.bfloat16) * 0.8)(B, Hq, Sq, D)),
        "k": _w((lambda *s: torch.randn(*s, dtype=torch.bfloat16) * 0.8)(B, Hkv, Sk, D)),
        "v": _w((lambda *s: torch.randn(*s, dtype=torch.bfloat16) * 0.05)(B, Hkv, Sk, D)),
    }

def reference(q, k, v):
    B, Hq, Sq, D = q.shape
    Hkv = k.shape[1]
    rep = Hq // Hkv
    k = (lambda x, n, axis: torch.repeat_interleave(x, n, dim=axis))(k, rep, axis=1)
    v = (lambda x, n, axis: torch.repeat_interleave(x, n, dim=axis))(v, rep, axis=1)
    scale = D ** -0.5
    scores = torch.einsum("bhqd,bhkd->bhqk", q, k) * scale
    p = _softmax(scores, axis=-1)
    return torch.einsum("bhqk,bhkd->bhqd", p, v)
```

```asm
; @launch grid=(256,1,1) block=(320,1,1) lds=163840
.amdgcn_target "amdgcn-amd-amdhsa--gfx950"
.text
.globl standalone__gqa_softmax__sampling_kernel
.p2align 8
.type standalone__gqa_softmax__sampling_kernel,@function
standalone__gqa_softmax__sampling_kernel:
s_cmp_ge_u32 s2, 256
s_cbranch_scc1 L_end
s_load_dwordx8 s[4:11], s[0:1], 0
s_load_dwordx4 s[12:15], s[0:1], 32
v_lshrrev_b32 v2, 6, v0
v_and_b32 v1, 63, v0
v_readfirstlane_b32 s40, v2
s_and_b32 s41, s2, 7
s_bfe_u32 s42, s2, 0x20003
s_lshr_b32 s52, s2, 5
s_lshl_b32 s52, s52, 3
s_add_u32 s41, s41, s52
s_cmp_lg_u32 s40, 4
s_cbranch_scc1 L_cons
s_setprio 3
v_lshrrev_b32 v3, 4, v1
v_and_b32 v4, 15, v1
v_lshlrev_b32 v5, 8, v3
v_xor_b32 v6, v4, v3
v_lshl_add_u32 v8, v6, 4, v5
v_xor_b32 v9, 64, v8
v_xor_b32 v10, 128, v8
v_xor_b32 v11, 192, v8
v_lshlrev_b32 v6, 1, v3
v_xor_b32 v6, v4, v6
v_lshl_add_u32 v12, v6, 4, v5
v_xor_b32 v13, 128, v12
s_lshl_b32 s55, s41, 15
s_lshl_b32 s56, s41, 21
s_mov_b32 s26, 0x8000
s_mov_b32 s27, 0x20000
s_mov_b32 s18, 0x200000
s_mov_b32 s19, 0x20000
s_mov_b32 s22, 0x200000
s_mov_b32 s23, 0x20000
s_mov_b32 s38, 0x100
s_mov_b32 s39, 0x20000
s_lshl_b32 s49, s42, 13
s_mov_b32 s78, 0
s_mov_b32 s79, -1
s_mov_b32 s50, 0x200000
s_mov_b32 s53, 0xc000
s_mov_b32 s54, 0
s_waitcnt lgkmcnt(0)
s_add_u32 s16, s6, s56
s_addc_u32 s17, s7, 0
s_add_u32 s24, s4, s55
s_addc_u32 s25, s5, 0
s_add_u32 s20, s8, s56
s_addc_u32 s21, s9, 0
s_mov_b32 m0, s53
s_add_u32 s56, s49, 0x1000
buffer_load_dwordx4 v8, s[16:19], s49 offen offset:0 nt lds
buffer_load_dwordx4 v9, s[16:19], s49 offen offset:1024 nt lds
buffer_load_dwordx4 v10, s[16:19], s49 offen offset:2048 nt lds
buffer_load_dwordx4 v11, s[16:19], s49 offen offset:3072 nt lds
s_add_u32 m0, s53, 0x1000
s_add_u32 s53, s53, 0x2000
buffer_load_dwordx4 v8, s[16:19], s56 offen offset:0 nt lds
buffer_load_dwordx4 v9, s[16:19], s56 offen offset:1024 nt lds
buffer_load_dwordx4 v10, s[16:19], s56 offen offset:2048 nt lds
buffer_load_dwordx4 v11, s[16:19], s56 offen offset:3072 nt lds
s_and_b32 s53, s53, 0xffff
s_add_u32 s78, s78, 1
s_bfe_u32 s49, s78, 0x20000
s_xor_b32 s49, s49, s42
s_lshr_b32 s56, s78, 0
s_lshl2_add_u32 s49, s56, s49
s_lshl_b32 s49, s49, 13
s_mov_b32 m0, 0x20000
s_mov_b32 s55, 0x0
buffer_load_dwordx4 v8, s[24:27], s55 offen offset:0 nt lds
buffer_load_dwordx4 v9, s[24:27], s55 offen offset:1024 nt lds
buffer_load_dwordx4 v10, s[24:27], s55 offen offset:2048 nt lds
buffer_load_dwordx4 v11, s[24:27], s55 offen offset:3072 nt lds
s_mov_b32 m0, 0x21000
s_mov_b32 s55, 0x1000
buffer_load_dwordx4 v8, s[24:27], s55 offen offset:0 nt lds
buffer_load_dwordx4 v9, s[24:27], s55 offen offset:1024 nt lds
buffer_load_dwordx4 v10, s[24:27], s55 offen offset:2048 nt lds
buffer_load_dwordx4 v11, s[24:27], s55 offen offset:3072 nt lds
s_mov_b32 m0, s53
s_add_u32 s56, s49, 0x1000
buffer_load_dwordx4 v8, s[16:19], s49 offen offset:0 nt lds
buffer_load_dwordx4 v9, s[16:19], s49 offen offset:1024 nt lds
buffer_load_dwordx4 v10, s[16:19], s49 offen offset:2048 nt lds
buffer_load_dwordx4 v11, s[16:19], s49 offen offset:3072 nt lds
s_add_u32 m0, s53, 0x1000
s_add_u32 s53, s53, 0x2000
buffer_load_dwordx4 v8, s[16:19], s56 offen offset:0 nt lds
buffer_load_dwordx4 v9, s[16:19], s56 offen offset:1024 nt lds
buffer_load_dwordx4 v10, s[16:19], s56 offen offset:2048 nt lds
buffer_load_dwordx4 v11, s[16:19], s56 offen offset:3072 nt lds
s_and_b32 s53, s53, 0xffff
s_add_u32 s78, s78, 1
s_bfe_u32 s49, s78, 0x20000
s_xor_b32 s49, s49, s42
s_lshr_b32 s56, s78, 0
s_lshl2_add_u32 s49, s56, s49
s_lshl_b32 s49, s49, 13
s_mov_b32 m0, 0x22000
s_mov_b32 s55, 0x2000
buffer_load_dwordx4 v8, s[24:27], s55 offen offset:0 nt lds
buffer_load_dwordx4 v9, s[24:27], s55 offen offset:1024 nt lds
buffer_load_dwordx4 v10, s[24:27], s55 offen offset:2048 nt lds
buffer_load_dwordx4 v11, s[24:27], s55 offen offset:3072 nt lds
s_mov_b32 m0, 0x23000
s_mov_b32 s55, 0x3000
buffer_load_dwordx4 v8, s[24:27], s55 offen offset:0 nt lds
buffer_load_dwordx4 v9, s[24:27], s55 offen offset:1024 nt lds
buffer_load_dwordx4 v10, s[24:27], s55 offen offset:2048 nt lds
buffer_load_dwordx4 v11, s[24:27], s55 offen offset:3072 nt lds
s_mov_b32 m0, s53
s_add_u32 s56, s49, 0x1000
buffer_load_dwordx4 v8, s[16:19], s49 offen offset:0 nt lds
buffer_load_dwordx4 v9, s[16:19], s49 offen offset:1024 nt lds
buffer_load_dwordx4 v10, s[16:19], s49 offen offset:2048 nt lds
buffer_load_dwordx4 v11, s[16:19], s49 offen offset:3072 nt lds
s_add_u32 m0, s53, 0x1000
s_add_u32 s53, s53, 0x2000
buffer_load_dwordx4 v8, s[16:19], s56 offen offset:0 nt lds
buffer_load_dwordx4 v9, s[16:19], s56 offen offset:1024 nt lds
buffer_load_dwordx4 v10, s[16:19], s56 offen offset:2048 nt lds
buffer_load_dwordx4 v11, s[16:19], s56 offen offset:3072 nt lds
s_and_b32 s53, s53, 0xffff
s_add_u32 s78, s78, 1
s_bfe_u32 s49, s78, 0x20000
s_xor_b32 s49, s49, s42
s_lshr_b32 s56, s78, 0
s_lshl2_add_u32 s49, s56, s49
s_lshl_b32 s49, s49, 13
s_add_u32 m0, s54, 0x10000
s_add_u32 s56, s50, 0x1000
buffer_load_dwordx4 v12, s[20:23], s50 offen offset:0 nt lds
buffer_load_dwordx4 v13, s[20:23], s50 offen offset:1024 nt lds
buffer_load_dwordx4 v12, s[20:23], s50 offen offset:2048 nt lds
buffer_load_dwordx4 v13, s[20:23], s50 offen offset:3072 nt lds
s_add_u32 m0, s54, 0x11000
s_add_u32 s54, s54, 0x2000
buffer_load_dwordx4 v12, s[20:23], s56 offen offset:0 nt lds
buffer_load_dwordx4 v13, s[20:23], s56 offen offset:1024 nt lds
buffer_load_dwordx4 v12, s[20:23], s56 offen offset:2048 nt lds
buffer_load_dwordx4 v13, s[20:23], s56 offen offset:3072 nt lds
s_and_b32 s54, s54, 0xffff
s_add_u32 s79, s79, 1
s_bfe_u32 s50, s79, 0x20000
s_xor_b32 s50, s50, s42
s_lshr_b32 s56, s79, 0
s_lshl2_add_u32 s50, s56, s50
s_lshl_b32 s50, s50, 13
s_mov_b32 m0, 0x24000
s_mov_b32 s55, 0x4000
buffer_load_dwordx4 v8, s[24:27], s55 offen offset:0 nt lds
buffer_load_dwordx4 v9, s[24:27], s55 offen offset:1024 nt lds
buffer_load_dwordx4 v10, s[24:27], s55 offen offset:2048 nt lds
buffer_load_dwordx4 v11, s[24:27], s55 offen offset:3072 nt lds
s_mov_b32 m0, 0x25000
s_mov_b32 s55, 0x5000
buffer_load_dwordx4 v8, s[24:27], s55 offen offset:0 nt lds
buffer_load_dwordx4 v9, s[24:27], s55 offen offset:1024 nt lds
buffer_load_dwordx4 v10, s[24:27], s55 offen offset:2048 nt lds
buffer_load_dwordx4 v11, s[24:27], s55 offen offset:3072 nt lds
s_mov_b32 m0, 0x26000
s_mov_b32 s55, 0x6000
buffer_load_dwordx4 v8, s[24:27], s55 offen offset:0 nt lds
buffer_load_dwordx4 v9, s[24:27], s55 offen offset:1024 nt lds
buffer_load_dwordx4 v10, s[24:27], s55 offen offset:2048 nt lds
buffer_load_dwordx4 v11, s[24:27], s55 offen offset:3072 nt lds
s_mov_b32 m0, 0x27000
s_mov_b32 s55, 0x7000
buffer_load_dwordx4 v8, s[24:27], s55 offen offset:0 nt lds
buffer_load_dwordx4 v9, s[24:27], s55 offen offset:1024 nt lds
buffer_load_dwordx4 v10, s[24:27], s55 offen offset:2048 nt lds
buffer_load_dwordx4 v11, s[24:27], s55 offen offset:3072 nt lds
s_mov_b32 m0, s53
s_add_u32 s56, s49, 0x1000
buffer_load_dwordx4 v8, s[16:19], s49 offen offset:0 nt lds
buffer_load_dwordx4 v9, s[16:19], s49 offen offset:1024 nt lds
buffer_load_dwordx4 v10, s[16:19], s49 offen offset:2048 nt lds
buffer_load_dwordx4 v11, s[16:19], s49 offen offset:3072 nt lds
s_add_u32 m0, s53, 0x1000
s_add_u32 s53, s53, 0x2000
buffer_load_dwordx4 v8, s[16:19], s56 offen offset:0 nt lds
buffer_load_dwordx4 v9, s[16:19], s56 offen offset:1024 nt lds
buffer_load_dwordx4 v10, s[16:19], s56 offen offset:2048 nt lds
buffer_load_dwordx4 v11, s[16:19], s56 offen offset:3072 nt lds
s_and_b32 s53, s53, 0xffff
s_add_u32 s78, s78, 1
s_bfe_u32 s49, s78, 0x20000
s_xor_b32 s49, s49, s42
s_lshr_b32 s56, s78, 0
s_lshl2_add_u32 s49, s56, s49
s_lshl_b32 s49, s49, 13
s_add_u32 m0, s54, 0x10000
s_add_u32 s56, s50, 0x1000
buffer_load_dwordx4 v12, s[20:23], s50 offen offset:0 nt lds
buffer_load_dwordx4 v13, s[20:23], s50 offen offset:1024 nt lds
buffer_load_dwordx4 v12, s[20:23], s50 offen offset:2048 nt lds
buffer_load_dwordx4 v13, s[20:23], s50 offen offset:3072 nt lds
s_add_u32 m0, s54, 0x11000
s_add_u32 s54, s54, 0x2000
buffer_load_dwordx4 v12, s[20:23], s56 offen offset:0 nt lds
buffer_load_dwordx4 v13, s[20:23], s56 offen offset:1024 nt lds
buffer_load_dwordx4 v12, s[20:23], s56 offen offset:2048 nt lds
buffer_load_dwordx4 v13, s[20:23], s56 offen offset:3072 nt lds
s_and_b32 s54, s54, 0xffff
s_add_u32 s79, s79, 1
s_bfe_u32 s50, s79, 0x20000
s_xor_b32 s50, s50, s42
s_lshr_b32 s56, s79, 0
s_lshl2_add_u32 s50, s56, s50
s_lshl_b32 s50, s50, 13
s_waitcnt vmcnt(16)
s_barrier
s_mov_b32 m0, s53
s_add_u32 s56, s49, 0x1000
buffer_load_dwordx4 v8, s[16:19], s49 offen offset:0 nt lds
buffer_load_dwordx4 v9, s[16:19], s49 offen offset:1024 nt lds
buffer_load_dwordx4 v10, s[16:19], s49 offen offset:2048 nt lds
buffer_load_dwordx4 v11, s[16:19], s49 offen offset:3072 nt lds
s_add_u32 m0, s53, 0x1000
s_add_u32 s53, s53, 0x2000
buffer_load_dwordx4 v8, s[16:19], s56 offen offset:0 nt lds
buffer_load_dwordx4 v9, s[16:19], s56 offen offset:1024 nt lds
buffer_load_dwordx4 v10, s[16:19], s56 offen offset:2048 nt lds
buffer_load_dwordx4 v11, s[16:19], s56 offen offset:3072 nt lds
s_and_b32 s53, s53, 0xffff
s_add_u32 s78, s78, 1
s_bfe_u32 s49, s78, 0x20000
s_xor_b32 s49, s49, s42
s_lshr_b32 s56, s78, 0
s_lshl2_add_u32 s49, s56, s49
s_lshl_b32 s49, s49, 13
s_add_u32 m0, s54, 0x10000
s_add_u32 s56, s50, 0x1000
buffer_load_dwordx4 v12, s[20:23], s50 offen offset:0 nt lds
buffer_load_dwordx4 v13, s[20:23], s50 offen offset:1024 nt lds
buffer_load_dwordx4 v12, s[20:23], s50 offen offset:2048 nt lds
buffer_load_dwordx4 v13, s[20:23], s50 offen offset:3072 nt lds
s_add_u32 m0, s54, 0x11000
s_add_u32 s54, s54, 0x2000
buffer_load_dwordx4 v12, s[20:23], s56 offen offset:0 nt lds
buffer_load_dwordx4 v13, s[20:23], s56 offen offset:1024 nt lds
buffer_load_dwordx4 v12, s[20:23], s56 offen offset:2048 nt lds
buffer_load_dwordx4 v13, s[20:23], s56 offen offset:3072 nt lds
s_and_b32 s54, s54, 0xffff
s_add_u32 s79, s79, 1
s_bfe_u32 s50, s79, 0x20000
s_xor_b32 s50, s50, s42
s_lshr_b32 s56, s79, 0
s_lshl2_add_u32 s50, s56, s50
s_lshl_b32 s50, s50, 13
s_mov_b32 m0, s53
s_add_u32 s56, s49, 0x1000
buffer_load_dwordx4 v8, s[16:19], s49 offen offset:0 nt lds
buffer_load_dwordx4 v9, s[16:19], s49 offen offset:1024 nt lds
buffer_load_dwordx4 v10, s[16:19], s49 offen offset:2048 nt lds
buffer_load_dwordx4 v11, s[16:19], s49 offen offset:3072 nt lds
s_add_u32 m0, s53, 0x1000
s_add_u32 s53, s53, 0x2000
buffer_load_dwordx4 v8, s[16:19], s56 offen offset:0 nt lds
buffer_load_dwordx4 v9, s[16:19], s56 offen offset:1024 nt lds
buffer_load_dwordx4 v10, s[16:19], s56 offen offset:2048 nt lds
buffer_load_dwordx4 v11, s[16:19], s56 offen offset:3072 nt lds
s_and_b32 s53, s53, 0xffff
s_add_u32 s78, s78, 1
s_bfe_u32 s49, s78, 0x20000
s_xor_b32 s49, s49, s42
s_lshr_b32 s56, s78, 0
s_lshl2_add_u32 s49, s56, s49
s_lshl_b32 s49, s49, 13
s_add_u32 m0, s54, 0x10000
s_add_u32 s56, s50, 0x1000
buffer_load_dwordx4 v12, s[20:23], s50 offen offset:0 nt lds
buffer_load_dwordx4 v13, s[20:23], s50 offen offset:1024 nt lds
buffer_load_dwordx4 v12, s[20:23], s50 offen offset:2048 nt lds
buffer_load_dwordx4 v13, s[20:23], s50 offen offset:3072 nt lds
s_add_u32 m0, s54, 0x11000
s_add_u32 s54, s54, 0x2000
buffer_load_dwordx4 v12, s[20:23], s56 offen offset:0 nt lds
buffer_load_dwordx4 v13, s[20:23], s56 offen offset:1024 nt lds
buffer_load_dwordx4 v12, s[20:23], s56 offen offset:2048 nt lds
buffer_load_dwordx4 v13, s[20:23], s56 offen offset:3072 nt lds
s_and_b32 s54, s54, 0xffff
s_add_u32 s79, s79, 1
s_bfe_u32 s50, s79, 0x20000
s_xor_b32 s50, s50, s42
s_lshr_b32 s56, s79, 0
s_lshl2_add_u32 s50, s56, s50
s_lshl_b32 s50, s50, 13
s_mov_b32 m0, s53
s_add_u32 s56, s49, 0x1000
buffer_load_dwordx4 v8, s[16:19], s49 offen offset:0 nt lds
buffer_load_dwordx4 v9, s[16:19], s49 offen offset:1024 nt lds
buffer_load_dwordx4 v10, s[16:19], s49 offen offset:2048 nt lds
buffer_load_dwordx4 v11, s[16:19], s49 offen offset:3072 nt lds
s_add_u32 m0, s53, 0x1000
s_add_u32 s53, s53, 0x2000
buffer_load_dwordx4 v8, s[16:19], s56 offen offset:0 nt lds
buffer_load_dwordx4 v9, s[16:19], s56 offen offset:1024 nt lds
buffer_load_dwordx4 v10, s[16:19], s56 offen offset:2048 nt lds
buffer_load_dwordx4 v11, s[16:19], s56 offen offset:3072 nt lds
s_and_b32 s53, s53, 0xffff
s_add_u32 s78, s78, 1
s_bfe_u32 s49, s78, 0x20000
s_xor_b32 s49, s49, s42
s_lshr_b32 s56, s78, 0
s_lshl2_add_u32 s49, s56, s49
s_lshl_b32 s49, s49, 13
s_add_u32 m0, s54, 0x10000
s_add_u32 s56, s50, 0x1000
buffer_load_dwordx4 v12, s[20:23], s50 offen offset:0 nt lds
buffer_load_dwordx4 v13, s[20:23], s50 offen offset:1024 nt lds
buffer_load_dwordx4 v12, s[20:23], s50 offen offset:2048 nt lds
buffer_load_dwordx4 v13, s[20:23], s50 offen offset:3072 nt lds
s_add_u32 m0, s54, 0x11000
s_add_u32 s54, s54, 0x2000
buffer_load_dwordx4 v12, s[20:23], s56 offen offset:0 nt lds
buffer_load_dwordx4 v13, s[20:23], s56 offen offset:1024 nt lds
buffer_load_dwordx4 v12, s[20:23], s56 offen offset:2048 nt lds
buffer_load_dwordx4 v13, s[20:23], s56 offen offset:3072 nt lds
s_and_b32 s54, s54, 0xffff
s_add_u32 s79, s79, 1
s_bfe_u32 s50, s79, 0x20000
s_xor_b32 s50, s50, s42
s_lshr_b32 s56, s79, 0
s_lshl2_add_u32 s50, s56, s50
s_lshl_b32 s50, s50, 13
s_mov_b32 s36, s12
s_mov_b32 s37, s13
s_mov_b32 s47, 3
v_lshlrev_b32 v16, 2, v1
s_lshr_b32 s62, s2, 3
s_mul_i32 s62, s62, 21
s_lshr_b32 s62, s62, 5
s_add_u32 s62, s62, 8
s_mov_b32 s46, 1
s_mov_b32 s52, 21
s_bfe_u32 s55, s2, 0x30003
s_mul_i32 s55, s55, 17408
s_lshr_b32 s56, s2, 6
s_lshl_b32 s56, s56, 8
s_add_u32 s55, s55, s56
s_add_u32 s55, s55, 0x1004000
s_add_u32 s32, s14, s55
s_addc_u32 s33, s15, 0
s_mov_b32 s34, 64
s_mov_b32 s35, 0x20000
s_mov_b32 s60, 17
s_mov_b32 s44, 0x110f0f0f
s_mov_b32 s45, 0x18181111
s_mov_b64 s[76:77], 0
s_mov_b32 s61, 0
s_mov_b32 s57, -1
v_lshlrev_b32 v17, 8, v1
s_mov_b32 s51, 1
s_mov_b32 s48, 60
L_ploop:
s_waitcnt vmcnt(16)
s_barrier
s_mov_b32 m0, s53
s_add_u32 s56, s49, 0x1000
buffer_load_dwordx4 v8, s[16:19], s49 offen offset:0 nt lds
buffer_load_dwordx4 v9, s[16:19], s49 offen offset:1024 nt lds
buffer_load_dwordx4 v10, s[16:19], s49 offen offset:2048 nt lds
buffer_load_dwordx4 v11, s[16:19], s49 offen offset:3072 nt lds
s_add_u32 m0, s53, 0x1000
s_add_u32 s53, s53, 0x2000
buffer_load_dwordx4 v8, s[16:19], s56 offen offset:0 nt lds
buffer_load_dwordx4 v9, s[16:19], s56 offen offset:1024 nt lds
buffer_load_dwordx4 v10, s[16:19], s56 offen offset:2048 nt lds
buffer_load_dwordx4 v11, s[16:19], s56 offen offset:3072 nt lds
s_and_b32 s53, s53, 0xffff
s_add_u32 s78, s78, 1
s_bfe_u32 s49, s78, 0x20000
s_xor_b32 s49, s49, s42
s_lshr_b32 s56, s78, 0
s_lshl2_add_u32 s49, s56, s49
s_lshl_b32 s49, s49, 13
s_bitcmp1_b64 s[76:77], s47
s_cbranch_scc1 L_ck
L_ckret:
s_cmp_eq_u32 s47, s57
s_cbranch_scc1 L_rk
L_rkret:
s_cmp_gt_u32 s60, 17
s_cbranch_scc1 L_iv0
s_waitcnt vmcnt(17)
s_cmp_gt_u32 s60, 15
s_cbranch_scc1 L_iv0
s_waitcnt vmcnt(15)
L_iv0:
s_add_u32 m0, s54, 0x10000
s_add_u32 s56, s50, 0x1000
buffer_load_dwordx4 v12, s[20:23], s50 offen offset:0 nt lds
buffer_load_dwordx4 v13, s[20:23], s50 offen offset:1024 nt lds
buffer_load_dwordx4 v12, s[20:23], s50 offen offset:2048 nt lds
buffer_load_dwordx4 v13, s[20:23], s50 offen offset:3072 nt lds
s_add_u32 m0, s54, 0x11000
s_add_u32 s54, s54, 0x2000
buffer_load_dwordx4 v12, s[20:23], s56 offen offset:0 nt lds
buffer_load_dwordx4 v13, s[20:23], s56 offen offset:1024 nt lds
buffer_load_dwordx4 v12, s[20:23], s56 offen offset:2048 nt lds
buffer_load_dwordx4 v13, s[20:23], s56 offen offset:3072 nt lds
s_and_b32 s54, s54, 0xffff
s_add_u32 s79, s79, 1
s_bfe_u32 s50, s79, 0x20000
s_xor_b32 s50, s50, s42
s_lshr_b32 s56, s79, 0
s_lshl2_add_u32 s50, s56, s50
s_lshl_b32 s50, s50, 13
s_sub_u32 s55, s47, 11
s_cmp_lt_u32 s55, 4
s_cbranch_scc1 L_h
L_hret:
s_add_u32 s47, s47, 1
s_cmp_eq_u32 s47, s62
s_cbranch_scc1 L_give
L_giveret:
s_cmp_lt_u32 s47, s48
s_cbranch_scc1 L_ploop
s_cmp_eq_u32 s80, 8
s_cbranch_scc0 L_hs
L_hsret:
s_cmp_eq_u32 s48, 55
s_cbranch_scc1 L_e2
s_waitcnt vmcnt(16)
s_barrier
s_add_u32 m0, s54, 0x10000
s_add_u32 s56, s50, 0x1000
buffer_load_dwordx4 v12, s[20:23], s50 offen offset:0 nt lds
buffer_load_dwordx4 v13, s[20:23], s50 offen offset:1024 nt lds
buffer_load_dwordx4 v12, s[20:23], s50 offen offset:2048 nt lds
buffer_load_dwordx4 v13, s[20:23], s50 offen offset:3072 nt lds
s_add_u32 m0, s54, 0x11000
s_add_u32 s54, s54, 0x2000
buffer_load_dwordx4 v12, s[20:23], s56 offen offset:0 nt lds
buffer_load_dwordx4 v13, s[20:23], s56 offen offset:1024 nt lds
buffer_load_dwordx4 v12, s[20:23], s56 offen offset:2048 nt lds
buffer_load_dwordx4 v13, s[20:23], s56 offen offset:3072 nt lds
s_and_b32 s54, s54, 0xffff
s_add_u32 s79, s79, 1
s_bfe_u32 s50, s79, 0x20000
s_xor_b32 s50, s50, s42
s_lshr_b32 s56, s79, 0
s_lshl2_add_u32 s50, s56, s50
s_lshl_b32 s50, s50, 13
s_add_u32 m0, s54, 0x10000
s_add_u32 s56, s50, 0x1000
buffer_load_dwordx4 v12, s[20:23], s50 offen offset:0 nt lds
buffer_load_dwordx4 v13, s[20:23], s50 offen offset:1024 nt lds
buffer_load_dwordx4 v12, s[20:23], s50 offen offset:2048 nt lds
buffer_load_dwordx4 v13, s[20:23], s50 offen offset:3072 nt lds
s_add_u32 m0, s54, 0x11000
s_add_u32 s54, s54, 0x2000
buffer_load_dwordx4 v12, s[20:23], s56 offen offset:0 nt lds
buffer_load_dwordx4 v13, s[20:23], s56 offen offset:1024 nt lds
buffer_load_dwordx4 v12, s[20:23], s56 offen offset:2048 nt lds
buffer_load_dwordx4 v13, s[20:23], s56 offen offset:3072 nt lds
s_and_b32 s54, s54, 0xffff
s_add_u32 s79, s79, 1
s_bfe_u32 s50, s79, 0x20000
s_xor_b32 s50, s50, s42
s_lshr_b32 s56, s79, 0
s_lshl2_add_u32 s50, s56, s50
s_lshl_b32 s50, s50, 13
s_add_u32 m0, s54, 0x10000
s_add_u32 s56, s50, 0x1000
buffer_load_dwordx4 v12, s[20:23], s50 offen offset:0 nt lds
buffer_load_dwordx4 v13, s[20:23], s50 offen offset:1024 nt lds
buffer_load_dwordx4 v12, s[20:23], s50 offen offset:2048 nt lds
buffer_load_dwordx4 v13, s[20:23], s50 offen offset:3072 nt lds
s_add_u32 m0, s54, 0x11000
s_add_u32 s54, s54, 0x2000
buffer_load_dwordx4 v12, s[20:23], s56 offen offset:0 nt lds
buffer_load_dwordx4 v13, s[20:23], s56 offen offset:1024 nt lds
buffer_load_dwordx4 v12, s[20:23], s56 offen offset:2048 nt lds
buffer_load_dwordx4 v13, s[20:23], s56 offen offset:3072 nt lds
s_and_b32 s54, s54, 0xffff
s_add_u32 s79, s79, 1
s_bfe_u32 s50, s79, 0x20000
s_xor_b32 s50, s50, s42
s_lshr_b32 s56, s79, 0
s_lshl2_add_u32 s50, s56, s50
s_lshl_b32 s50, s50, 13
s_waitcnt vmcnt(24)
s_barrier
s_waitcnt vmcnt(16)
s_barrier
s_waitcnt vmcnt(8)
s_barrier
s_branch L_e3
L_e2:
s_waitcnt vmcnt(16)
s_barrier
s_mov_b32 m0, s53
s_add_u32 s56, s49, 0x1000
buffer_load_dwordx4 v8, s[16:19], s49 offen offset:0 nt lds
buffer_load_dwordx4 v9, s[16:19], s49 offen offset:1024 nt lds
buffer_load_dwordx4 v10, s[16:19], s49 offen offset:2048 nt lds
buffer_load_dwordx4 v11, s[16:19], s49 offen offset:3072 nt lds
s_add_u32 m0, s53, 0x1000
s_add_u32 s53, s53, 0x2000
buffer_load_dwordx4 v8, s[16:19], s56 offen offset:0 nt lds
buffer_load_dwordx4 v9, s[16:19], s56 offen offset:1024 nt lds
buffer_load_dwordx4 v10, s[16:19], s56 offen offset:2048 nt lds
buffer_load_dwordx4 v11, s[16:19], s56 offen offset:3072 nt lds
s_and_b32 s53, s53, 0xffff
s_add_u32 s78, s78, 1
s_bfe_u32 s49, s78, 0x20000
s_xor_b32 s49, s49, s42
s_lshr_b32 s56, s78, 0
s_lshl2_add_u32 s49, s56, s49
s_lshl_b32 s49, s49, 13
s_add_u32 m0, s54, 0x10000
s_add_u32 s56, s50, 0x1000
buffer_load_dwordx4 v12, s[20:23], s50 offen offset:0 nt lds
buffer_load_dwordx4 v13, s[20:23], s50 offen offset:1024 nt lds
buffer_load_dwordx4 v12, s[20:23], s50 offen offset:2048 nt lds
buffer_load_dwordx4 v13, s[20:23], s50 offen offset:3072 nt lds
s_add_u32 m0, s54, 0x11000
s_add_u32 s54, s54, 0x2000
buffer_load_dwordx4 v12, s[20:23], s56 offen offset:0 nt lds
buffer_load_dwordx4 v13, s[20:23], s56 offen offset:1024 nt lds
buffer_load_dwordx4 v12, s[20:23], s56 offen offset:2048 nt lds
buffer_load_dwordx4 v13, s[20:23], s56 offen offset:3072 nt lds
s_and_b32 s54, s54, 0xffff
s_add_u32 s79, s79, 1
s_bfe_u32 s50, s79, 0x20000
s_xor_b32 s50, s50, s42
s_lshr_b32 s56, s79, 0
s_lshl2_add_u32 s50, s56, s50
s_lshl_b32 s50, s50, 13
s_mov_b32 m0, s53
s_add_u32 s56, s49, 0x1000
buffer_load_dwordx4 v8, s[16:19], s49 offen offset:0 nt lds
buffer_load_dwordx4 v9, s[16:19], s49 offen offset:1024 nt lds
buffer_load_dwordx4 v10, s[16:19], s49 offen offset:2048 nt lds
buffer_load_dwordx4 v11, s[16:19], s49 offen offset:3072 nt lds
s_add_u32 m0, s53, 0x1000
s_add_u32 s53, s53, 0x2000
buffer_load_dwordx4 v8, s[16:19], s56 offen offset:0 nt lds
buffer_load_dwordx4 v9, s[16:19], s56 offen offset:1024 nt lds
buffer_load_dwordx4 v10, s[16:19], s56 offen offset:2048 nt lds
buffer_load_dwordx4 v11, s[16:19], s56 offen offset:3072 nt lds
s_and_b32 s53, s53, 0xffff
s_add_u32 s78, s78, 1
s_bfe_u32 s49, s78, 0x20000
s_xor_b32 s49, s49, s42
s_lshr_b32 s56, s78, 0
s_lshl2_add_u32 s49, s56, s49
s_lshl_b32 s49, s49, 13
s_waitcnt vmcnt(24)
s_barrier
s_add_u32 m0, s54, 0x10000
s_add_u32 s56, s50, 0x1000
buffer_load_dwordx4 v12, s[20:23], s50 offen offset:0 nt lds
buffer_load_dwordx4 v13, s[20:23], s50 offen offset:1024 nt lds
buffer_load_dwordx4 v12, s[20:23], s50 offen offset:2048 nt lds
buffer_load_dwordx4 v13, s[20:23], s50 offen offset:3072 nt lds
s_add_u32 m0, s54, 0x11000
s_add_u32 s54, s54, 0x2000
buffer_load_dwordx4 v12, s[20:23], s56 offen offset:0 nt lds
buffer_load_dwordx4 v13, s[20:23], s56 offen offset:1024 nt lds
buffer_load_dwordx4 v12, s[20:23], s56 offen offset:2048 nt lds
buffer_load_dwordx4 v13, s[20:23], s56 offen offset:3072 nt lds
s_and_b32 s54, s54, 0xffff
s_add_u32 s79, s79, 1
s_bfe_u32 s50, s79, 0x20000
s_xor_b32 s50, s50, s42
s_lshr_b32 s56, s79, 0
s_lshl2_add_u32 s50, s56, s50
s_lshl_b32 s50, s50, 13
s_mov_b32 m0, s53
s_add_u32 s56, s49, 0x1000
buffer_load_dwordx4 v8, s[16:19], s49 offen offset:0 nt lds
buffer_load_dwordx4 v9, s[16:19], s49 offen offset:1024 nt lds
buffer_load_dwordx4 v10, s[16:19], s49 offen offset:2048 nt lds
buffer_load_dwordx4 v11, s[16:19], s49 offen offset:3072 nt lds
s_add_u32 m0, s53, 0x1000
s_add_u32 s53, s53, 0x2000
buffer_load_dwordx4 v8, s[16:19], s56 offen offset:0 nt lds
buffer_load_dwordx4 v9, s[16:19], s56 offen offset:1024 nt lds
buffer_load_dwordx4 v10, s[16:19], s56 offen offset:2048 nt lds
buffer_load_dwordx4 v11, s[16:19], s56 offen offset:3072 nt lds
s_and_b32 s53, s53, 0xffff
s_add_u32 s78, s78, 1
s_bfe_u32 s49, s78, 0x20000
s_xor_b32 s49, s49, s42
s_lshr_b32 s56, s78, 0
s_lshl2_add_u32 s49, s56, s49
s_lshl_b32 s49, s49, 13
s_waitcnt vmcnt(24)
s_barrier
s_add_u32 m0, s54, 0x10000
s_add_u32 s56, s50, 0x1000
buffer_load_dwordx4 v12, s[20:23], s50 offen offset:0 nt lds
buffer_load_dwordx4 v13, s[20:23], s50 offen offset:1024 nt lds
buffer_load_dwordx4 v12, s[20:23], s50 offen offset:2048 nt lds
buffer_load_dwordx4 v13, s[20:23], s50 offen offset:3072 nt lds
s_add_u32 m0, s54, 0x11000
s_add_u32 s54, s54, 0x2000
buffer_load_dwordx4 v12, s[20:23], s56 offen offset:0 nt lds
buffer_load_dwordx4 v13, s[20:23], s56 offen offset:1024 nt lds
buffer_load_dwordx4 v12, s[20:23], s56 offen offset:2048 nt lds
buffer_load_dwordx4 v13, s[20:23], s56 offen offset:3072 nt lds
s_and_b32 s54, s54, 0xffff
s_add_u32 s79, s79, 1
s_bfe_u32 s50, s79, 0x20000
s_xor_b32 s50, s50, s42
s_lshr_b32 s56, s79, 0
s_lshl2_add_u32 s50, s56, s50
s_lshl_b32 s50, s50, 13
s_mov_b32 m0, s53
s_add_u32 s56, s49, 0x1000
buffer_load_dwordx4 v8, s[16:19], s49 offen offset:0 nt lds
buffer_load_dwordx4 v9, s[16:19], s49 offen offset:1024 nt lds
buffer_load_dwordx4 v10, s[16:19], s49 offen offset:2048 nt lds
buffer_load_dwordx4 v11, s[16:19], s49 offen offset:3072 nt lds
s_add_u32 m0, s53, 0x1000
s_add_u32 s53, s53, 0x2000
buffer_load_dwordx4 v8, s[16:19], s56 offen offset:0 nt lds
buffer_load_dwordx4 v9, s[16:19], s56 offen offset:1024 nt lds
buffer_load_dwordx4 v10, s[16:19], s56 offen offset:2048 nt lds
buffer_load_dwordx4 v11, s[16:19], s56 offen offset:3072 nt lds
s_and_b32 s53, s53, 0xffff
s_add_u32 s78, s78, 1
s_bfe_u32 s49, s78, 0x20000
s_xor_b32 s49, s49, s42
s_lshr_b32 s56, s78, 0
s_lshl2_add_u32 s49, s56, s49
s_lshl_b32 s49, s49, 13
s_waitcnt vmcnt(24)
s_barrier
s_add_u32 m0, s54, 0x10000
s_add_u32 s56, s50, 0x1000
buffer_load_dwordx4 v12, s[20:23], s50 offen offset:0 nt lds
buffer_load_dwordx4 v13, s[20:23], s50 offen offset:1024 nt lds
buffer_load_dwordx4 v12, s[20:23], s50 offen offset:2048 nt lds
buffer_load_dwordx4 v13, s[20:23], s50 offen offset:3072 nt lds
s_add_u32 m0, s54, 0x11000
s_add_u32 s54, s54, 0x2000
buffer_load_dwordx4 v12, s[20:23], s56 offen offset:0 nt lds
buffer_load_dwordx4 v13, s[20:23], s56 offen offset:1024 nt lds
buffer_load_dwordx4 v12, s[20:23], s56 offen offset:2048 nt lds
buffer_load_dwordx4 v13, s[20:23], s56 offen offset:3072 nt lds
s_and_b32 s54, s54, 0xffff
s_add_u32 s79, s79, 1
s_bfe_u32 s50, s79, 0x20000
s_xor_b32 s50, s50, s42
s_lshr_b32 s56, s79, 0
s_lshl2_add_u32 s50, s56, s50
s_lshl_b32 s50, s50, 13
s_mov_b32 m0, s53
s_add_u32 s56, s49, 0x1000
buffer_load_dwordx4 v8, s[16:19], s49 offen offset:0 nt lds
buffer_load_dwordx4 v9, s[16:19], s49 offen offset:1024 nt lds
buffer_load_dwordx4 v10, s[16:19], s49 offen offset:2048 nt lds
buffer_load_dwordx4 v11, s[16:19], s49 offen offset:3072 nt lds
s_add_u32 m0, s53, 0x1000
s_add_u32 s53, s53, 0x2000
buffer_load_dwordx4 v8, s[16:19], s56 offen offset:0 nt lds
buffer_load_dwordx4 v9, s[16:19], s56 offen offset:1024 nt lds
buffer_load_dwordx4 v10, s[16:19], s56 offen offset:2048 nt lds
buffer_load_dwordx4 v11, s[16:19], s56 offen offset:3072 nt lds
s_and_b32 s53, s53, 0xffff
s_add_u32 s78, s78, 1
s_bfe_u32 s49, s78, 0x20000
s_xor_b32 s49, s49, s42
s_lshr_b32 s56, s78, 0
s_lshl2_add_u32 s49, s56, s49
s_lshl_b32 s49, s49, 13
s_waitcnt vmcnt(24)
s_barrier
s_add_u32 m0, s54, 0x10000
s_add_u32 s56, s50, 0x1000
buffer_load_dwordx4 v12, s[20:23], s50 offen offset:0 nt lds
buffer_load_dwordx4 v13, s[20:23], s50 offen offset:1024 nt lds
buffer_load_dwordx4 v12, s[20:23], s50 offen offset:2048 nt lds
buffer_load_dwordx4 v13, s[20:23], s50 offen offset:3072 nt lds
s_add_u32 m0, s54, 0x11000
s_add_u32 s54, s54, 0x2000
buffer_load_dwordx4 v12, s[20:23], s56 offen offset:0 nt lds
buffer_load_dwordx4 v13, s[20:23], s56 offen offset:1024 nt lds
buffer_load_dwordx4 v12, s[20:23], s56 offen offset:2048 nt lds
buffer_load_dwordx4 v13, s[20:23], s56 offen offset:3072 nt lds
s_and_b32 s54, s54, 0xffff
s_add_u32 s79, s79, 1
s_bfe_u32 s50, s79, 0x20000
s_xor_b32 s50, s50, s42
s_lshr_b32 s56, s79, 0
s_lshl2_add_u32 s50, s56, s50
s_lshl_b32 s50, s50, 13
s_add_u32 m0, s54, 0x10000
s_add_u32 s56, s50, 0x1000
buffer_load_dwordx4 v12, s[20:23], s50 offen offset:0 nt lds
buffer_load_dwordx4 v13, s[20:23], s50 offen offset:1024 nt lds
buffer_load_dwordx4 v12, s[20:23], s50 offen offset:2048 nt lds
buffer_load_dwordx4 v13, s[20:23], s50 offen offset:3072 nt lds
s_add_u32 m0, s54, 0x11000
s_add_u32 s54, s54, 0x2000
buffer_load_dwordx4 v12, s[20:23], s56 offen offset:0 nt lds
buffer_load_dwordx4 v13, s[20:23], s56 offen offset:1024 nt lds
buffer_load_dwordx4 v12, s[20:23], s56 offen offset:2048 nt lds
buffer_load_dwordx4 v13, s[20:23], s56 offen offset:3072 nt lds
s_and_b32 s54, s54, 0xffff
s_add_u32 s79, s79, 1
s_bfe_u32 s50, s79, 0x20000
s_xor_b32 s50, s50, s42
s_lshr_b32 s56, s79, 0
s_lshl2_add_u32 s50, s56, s50
s_lshl_b32 s50, s50, 13
s_waitcnt vmcnt(24)
s_barrier
s_add_u32 m0, s54, 0x10000
s_add_u32 s56, s50, 0x1000
buffer_load_dwordx4 v12, s[20:23], s50 offen offset:0 nt lds
buffer_load_dwordx4 v13, s[20:23], s50 offen offset:1024 nt lds
buffer_load_dwordx4 v12, s[20:23], s50 offen offset:2048 nt lds
buffer_load_dwordx4 v13, s[20:23], s50 offen offset:3072 nt lds
s_add_u32 m0, s54, 0x11000
s_add_u32 s54, s54, 0x2000
buffer_load_dwordx4 v12, s[20:23], s56 offen offset:0 nt lds
buffer_load_dwordx4 v13, s[20:23], s56 offen offset:1024 nt lds
buffer_load_dwordx4 v12, s[20:23], s56 offen offset:2048 nt lds
buffer_load_dwordx4 v13, s[20:23], s56 offen offset:3072 nt lds
s_and_b32 s54, s54, 0xffff
s_add_u32 s79, s79, 1
s_bfe_u32 s50, s79, 0x20000
s_xor_b32 s50, s50, s42
s_lshr_b32 s56, s79, 0
s_lshl2_add_u32 s50, s56, s50
s_lshl_b32 s50, s50, 13
s_add_u32 m0, s54, 0x10000
s_add_u32 s56, s50, 0x1000
buffer_load_dwordx4 v12, s[20:23], s50 offen offset:0 nt lds
buffer_load_dwordx4 v13, s[20:23], s50 offen offset:1024 nt lds
buffer_load_dwordx4 v12, s[20:23], s50 offen offset:2048 nt lds
buffer_load_dwordx4 v13, s[20:23], s50 offen offset:3072 nt lds
s_add_u32 m0, s54, 0x11000
s_add_u32 s54, s54, 0x2000
buffer_load_dwordx4 v12, s[20:23], s56 offen offset:0 nt lds
buffer_load_dwordx4 v13, s[20:23], s56 offen offset:1024 nt lds
buffer_load_dwordx4 v12, s[20:23], s56 offen offset:2048 nt lds
buffer_load_dwordx4 v13, s[20:23], s56 offen offset:3072 nt lds
s_and_b32 s54, s54, 0xffff
s_add_u32 s79, s79, 1
s_bfe_u32 s50, s79, 0x20000
s_xor_b32 s50, s50, s42
s_lshr_b32 s56, s79, 0
s_lshl2_add_u32 s50, s56, s50
s_lshl_b32 s50, s50, 13
s_waitcnt vmcnt(24)
s_barrier
s_waitcnt vmcnt(16)
s_barrier
s_waitcnt vmcnt(8)
s_barrier
L_e3:
s_waitcnt vmcnt(0)
s_barrier
L_kb:
s_sub_u32 s51, s51, 1
s_cbranch_scc1 L_kd
s_barrier
s_branch L_kb
L_kd:
s_endpgm
L_give:
s_add_u32 s62, s62, s52
s_sub_u32 s46, s46, 1
s_cselect_b32 s62, -1, s62
s_barrier
s_branch L_giveret
L_h:
s_cmp_eq_u32 s55, 3
s_cbranch_scc1 L_h3
s_cmp_eq_u32 s55, 0
s_cbranch_scc0 L_hret
buffer_load_dword v19, v16, s[36:39], 0 offen
s_branch L_hret
L_h3:
v_cmp_eq_u32 vcc, 1, v19
s_bcnt1_i32_b64 s80, vcc
s_cmp_eq_u32 s80, 8
s_cselect_b32 s76, 0x0, 0
s_cselect_b32 s77, 0x20020, 0
s_branch L_hret
L_ck:
v_mov_b32 v18, 1
buffer_atomic_add v18, v17, s[32:35], s61 offen sc0
s_add_u32 s61, s61, 4
s_add_u32 s57, s47, 2
s_branch L_ckret
L_rk:
v_readfirstlane_b32 s55, v18
s_lshl_b32 s55, s55, 3
s_lshr_b64 s[90:91], s[44:45], s55
s_and_b32 s60, s90, 0xff
s_cmp_eq_u32 s47, 51
s_cbranch_scc0 L_rkret
s_lshr_b32 s55, s55, 1
s_lshr_b32 s55, 0x11000000, s55
s_and_b32 s55, s55, 15
s_cbranch_scc0 L_rkret
s_sub_u32 s51, s51, s55
s_sub_u32 s46, s55, 1
s_add_u32 s62, s47, 1
s_mov_b32 s52, 2
s_mov_b32 s48, 55
s_branch L_rkret
L_hs:
s_mov_b32 s63, 0x200000
L_hs1:
buffer_load_dword v19, v16, s[36:39], 0 offen sc1
s_waitcnt vmcnt(0)
v_cmp_eq_u32 vcc, 1, v19
s_bcnt1_i32_b64 s80, vcc
s_cmp_eq_u32 s80, 8
s_cbranch_scc1 L_hsret
s_sub_u32 s63, s63, 1
s_cbranch_scc0 L_hs1
s_branch L_hsret
.p2align 6
L_cons:
v_and_b32 v3, 15, v1
v_lshrrev_b32 v4, 4, v1
v_lshlrev_b32 v5, 8, v3
s_lshl_b32 s52, s41, 2
s_add_u32 s54, s52, s40
s_lshl_b32 s55, s54, 13
s_and_b32 s56, s54, 0
s_lshl_b32 s56, s56, 12
s_lshr_b32 s54, s54, 0
s_mul_i32 s54, s54, 32768
s_add_u32 s54, s54, s56
s_mov_b32 s30, 0x2000
s_mov_b32 s31, 0x20000
s_mov_b32 s34, 0x6000
s_mov_b32 s35, 0x20000
s_mov_b32 s38, 0x100
s_mov_b32 s39, 0x20000
s_mov_b32 s26, 0x4400
s_mov_b32 s27, 0x20000
s_and_b32 s57, s2, 7
s_mul_i32 s57, s57, 17408
s_add_u32 s57, s57, 0x1000000
s_mov_b32 s48, 0x3e0293ee
v_lshlrev_b32 v24, 4, v4
v_xor_b32 v7, v4, v3
v_lshl_add_u32 v8, v7, 4, v5
v_xor_b32 v9, 64, v8
v_xor_b32 v10, 128, v8
v_xor_b32 v11, 192, v8
v_lshrrev_b32 v7, 2, v1
v_lshlrev_b32 v2, 8, v7
v_and_b32 v7, 7, v7
s_and_b32 s58, s42, 2
s_lshl_b32 s58, s58, 1
v_xor_b32 v7, s58, v7
v_lshl_add_u32 v2, v7, 5, v2
v_and_b32 v7, 3, v1
v_lshl_add_u32 v2, v7, 3, v2
v_add_u32 v12, 0x10000, v2
v_xor_b32 v13, 32, v12
v_xor_b32 v14, 64, v12
v_xor_b32 v15, 96, v12
v_xor_b32 v16, 128, v12
v_xor_b32 v17, 160, v12
v_xor_b32 v18, 192, v12
v_xor_b32 v19, 224, v12
v_cmp_eq_u32 vcc, 0, v7
s_lshl_b32 s58, s40, 1
s_and_b32 s60, s42, 1
s_add_u32 s58, s58, s60
s_lshl_b32 s58, s58, 12
s_add_u32 s58, s58, 0x20000
v_add_u32 v176, s58, v8
v_add_u32 v177, s58, v9
v_add_u32 v178, s58, v10
v_add_u32 v179, s58, v11
v_xor_b32 v180, 0x1000, v176
v_xor_b32 v181, 0x1000, v177
v_xor_b32 v182, 0x1000, v178
v_xor_b32 v183, 0x1000, v179
v_mov_b32 v2, 0x3f803f80
v_cndmask_b32 v20, 0, v2, vcc
v_cndmask_b32 v21, 0, v2, vcc
v_cndmask_b32 v22, 0, v2, vcc
v_cndmask_b32 v23, 0, v2, vcc
v_mov_b32 v64, 0
v_mov_b32 v65, 0
v_mov_b32 v66, 0
v_mov_b32 v67, 0
v_mov_b32 v68, 0
v_mov_b32 v69, 0
v_mov_b32 v70, 0
v_mov_b32 v71, 0
v_mov_b32 v72, 0
v_mov_b32 v73, 0
v_mov_b32 v74, 0
v_mov_b32 v75, 0
v_mov_b32 v76, 0
v_mov_b32 v77, 0
v_mov_b32 v78, 0
v_mov_b32 v79, 0
v_mov_b32 v80, 0
v_mov_b32 v81, 0
v_mov_b32 v82, 0
v_mov_b32 v83, 0
v_mov_b32 v84, 0
v_mov_b32 v85, 0
v_mov_b32 v86, 0
v_mov_b32 v87, 0
v_mov_b32 v88, 0
v_mov_b32 v89, 0
v_mov_b32 v90, 0
v_mov_b32 v91, 0
v_mov_b32 v92, 0
v_mov_b32 v93, 0
v_mov_b32 v94, 0
v_mov_b32 v95, 0
v_mov_b32 v96, 0
v_mov_b32 v97, 0
v_mov_b32 v98, 0
v_mov_b32 v99, 0
v_mov_b32 v100, 0
v_mov_b32 v101, 0
v_mov_b32 v102, 0
v_mov_b32 v103, 0
v_mov_b32 v104, 0
v_mov_b32 v105, 0
v_mov_b32 v106, 0
v_mov_b32 v107, 0
v_mov_b32 v108, 0
v_mov_b32 v109, 0
v_mov_b32 v110, 0
v_mov_b32 v111, 0
v_mov_b32 v112, 0
v_mov_b32 v113, 0
v_mov_b32 v114, 0
v_mov_b32 v115, 0
v_mov_b32 v116, 0
v_mov_b32 v117, 0
v_mov_b32 v118, 0
v_mov_b32 v119, 0
v_mov_b32 v120, 0
v_mov_b32 v121, 0
v_mov_b32 v122, 0
v_mov_b32 v123, 0
v_mov_b32 v124, 0
v_mov_b32 v125, 0
v_mov_b32 v126, 0
v_mov_b32 v127, 0
v_mov_b32 v56, 0
v_mov_b32 v57, 0
v_mov_b32 v58, 0
v_mov_b32 v59, 0
v_mov_b32 v60, 0
v_mov_b32 v61, 0
v_mov_b32 v62, 0
v_mov_b32 v63, 0
v_mov_b32 v25, 0
v_mov_b32 v26, 0
s_mov_b32 s47, 0
s_mov_b32 s49, 0x44800000
s_waitcnt lgkmcnt(0)
s_add_u32 s32, s14, s54
s_addc_u32 s33, s15, 0
s_add_u32 s28, s10, s55
s_addc_u32 s29, s11, 0
s_mov_b32 s36, s12
s_mov_b32 s37, s13
s_add_u32 s24, s14, s57
s_addc_u32 s25, s15, 0
s_lshr_b32 s61, s2, 5
s_and_b32 s59, s61, 7
s_xor_b32 s59, s59, s2
s_and_b32 s59, s59, 31
s_or_b32 s59, s59, s40
s_cbranch_scc1 L_noreset
s_mul_i32 s60, s61, 17408
s_add_u32 s60, s60, 0x1000000
s_add_u32 s20, s14, s60
s_addc_u32 s21, s15, 0
s_mov_b32 s22, 17408
s_mov_b32 s23, 0x20000
v_lshlrev_b32 v6, 4, v1
s_mov_b32 s60, 0
buffer_store_dwordx4 v[64:67], v6, s[20:23], s60 offen offset:0 sc1
buffer_store_dwordx4 v[64:67], v6, s[20:23], s60 offen offset:1024 sc1
buffer_store_dwordx4 v[64:67], v6, s[20:23], s60 offen offset:2048 sc1
buffer_store_dwordx4 v[64:67], v6, s[20:23], s60 offen offset:3072 sc1
s_mov_b32 s60, 4096
buffer_store_dwordx4 v[64:67], v6, s[20:23], s60 offen offset:0 sc1
buffer_store_dwordx4 v[64:67], v6, s[20:23], s60 offen offset:1024 sc1
buffer_store_dwordx4 v[64:67], v6, s[20:23], s60 offen offset:2048 sc1
buffer_store_dwordx4 v[64:67], v6, s[20:23], s60 offen offset:3072 sc1
s_mov_b32 s60, 8192
buffer_store_dwordx4 v[64:67], v6, s[20:23], s60 offen offset:0 sc1
buffer_store_dwordx4 v[64:67], v6, s[20:23], s60 offen offset:1024 sc1
buffer_store_dwordx4 v[64:67], v6, s[20:23], s60 offen offset:2048 sc1
buffer_store_dwordx4 v[64:67], v6, s[20:23], s60 offen offset:3072 sc1
s_mov_b32 s60, 12288
buffer_store_dwordx4 v[64:67], v6, s[20:23], s60 offen offset:0 sc1
buffer_store_dwordx4 v[64:67], v6, s[20:23], s60 offen offset:1024 sc1
buffer_store_dwordx4 v[64:67], v6, s[20:23], s60 offen offset:2048 sc1
buffer_store_dwordx4 v[64:67], v6, s[20:23], s60 offen offset:3072 sc1
s_mov_b32 s60, 16384
buffer_store_dwordx4 v[64:67], v6, s[20:23], s60 offen offset:0 sc1
L_noreset:
s_barrier
ds_read_b128 v[128:131], v176
ds_read_b128 v[132:135], v177
ds_read_b128 v[136:139], v178
ds_read_b128 v[140:143], v179
ds_read_b128 v[144:147], v180
ds_read_b128 v[148:151], v181
ds_read_b128 v[152:155], v182
ds_read_b128 v[156:159], v183
s_waitcnt lgkmcnt(7)
v_lshlrev_b32 v2, 16, v128
v_and_b32 v3, 0xffff0000, v128
v_mul_f32 v2, s48, v2
v_mul_f32 v3, s48, v3
v_cvt_pk_bf16_f32 v128, v2, v3
v_lshlrev_b32 v2, 16, v129
v_and_b32 v3, 0xffff0000, v129
v_mul_f32 v2, s48, v2
v_mul_f32 v3, s48, v3
v_cvt_pk_bf16_f32 v129, v2, v3
v_lshlrev_b32 v2, 16, v130
v_and_b32 v3, 0xffff0000, v130
v_mul_f32 v2, s48, v2
v_mul_f32 v3, s48, v3
v_cvt_pk_bf16_f32 v130, v2, v3
v_lshlrev_b32 v2, 16, v131
v_and_b32 v3, 0xffff0000, v131
v_mul_f32 v2, s48, v2
v_mul_f32 v3, s48, v3
v_cvt_pk_bf16_f32 v131, v2, v3
s_waitcnt lgkmcnt(6)
v_lshlrev_b32 v2, 16, v132
v_and_b32 v3, 0xffff0000, v132
v_mul_f32 v2, s48, v2
v_mul_f32 v3, s48, v3
v_cvt_pk_bf16_f32 v132, v2, v3
v_lshlrev_b32 v2, 16, v133
v_and_b32 v3, 0xffff0000, v133
v_mul_f32 v2, s48, v2
v_mul_f32 v3, s48, v3
v_cvt_pk_bf16_f32 v133, v2, v3
v_lshlrev_b32 v2, 16, v134
v_and_b32 v3, 0xffff0000, v134
v_mul_f32 v2, s48, v2
v_mul_f32 v3, s48, v3
v_cvt_pk_bf16_f32 v134, v2, v3
v_lshlrev_b32 v2, 16, v135
v_and_b32 v3, 0xffff0000, v135
v_mul_f32 v2, s48, v2
v_mul_f32 v3, s48, v3
v_cvt_pk_bf16_f32 v135, v2, v3
s_waitcnt lgkmcnt(5)
v_lshlrev_b32 v2, 16, v136
v_and_b32 v3, 0xffff0000, v136
v_mul_f32 v2, s48, v2
v_mul_f32 v3, s48, v3
v_cvt_pk_bf16_f32 v136, v2, v3
v_lshlrev_b32 v2, 16, v137
v_and_b32 v3, 0xffff0000, v137
v_mul_f32 v2, s48, v2
v_mul_f32 v3, s48, v3
v_cvt_pk_bf16_f32 v137, v2, v3
v_lshlrev_b32 v2, 16, v138
v_and_b32 v3, 0xffff0000, v138
v_mul_f32 v2, s48, v2
v_mul_f32 v3, s48, v3
v_cvt_pk_bf16_f32 v138, v2, v3
v_lshlrev_b32 v2, 16, v139
v_and_b32 v3, 0xffff0000, v139
v_mul_f32 v2, s48, v2
v_mul_f32 v3, s48, v3
v_cvt_pk_bf16_f32 v139, v2, v3
s_waitcnt lgkmcnt(4)
v_lshlrev_b32 v2, 16, v140
v_and_b32 v3, 0xffff0000, v140
v_mul_f32 v2, s48, v2
v_mul_f32 v3, s48, v3
v_cvt_pk_bf16_f32 v140, v2, v3
v_lshlrev_b32 v2, 16, v141
v_and_b32 v3, 0xffff0000, v141
v_mul_f32 v2, s48, v2
v_mul_f32 v3, s48, v3
v_cvt_pk_bf16_f32 v141, v2, v3
v_lshlrev_b32 v2, 16, v142
v_and_b32 v3, 0xffff0000, v142
v_mul_f32 v2, s48, v2
v_mul_f32 v3, s48, v3
v_cvt_pk_bf16_f32 v142, v2, v3
v_lshlrev_b32 v2, 16, v143
v_and_b32 v3, 0xffff0000, v143
v_mul_f32 v2, s48, v2
v_mul_f32 v3, s48, v3
v_cvt_pk_bf16_f32 v143, v2, v3
s_waitcnt lgkmcnt(3)
v_lshlrev_b32 v2, 16, v144
v_and_b32 v3, 0xffff0000, v144
v_mul_f32 v2, s48, v2
v_mul_f32 v3, s48, v3
v_cvt_pk_bf16_f32 v144, v2, v3
v_lshlrev_b32 v2, 16, v145
v_and_b32 v3, 0xffff0000, v145
v_mul_f32 v2, s48, v2
v_mul_f32 v3, s48, v3
v_cvt_pk_bf16_f32 v145, v2, v3
v_lshlrev_b32 v2, 16, v146
v_and_b32 v3, 0xffff0000, v146
v_mul_f32 v2, s48, v2
v_mul_f32 v3, s48, v3
v_cvt_pk_bf16_f32 v146, v2, v3
v_lshlrev_b32 v2, 16, v147
v_and_b32 v3, 0xffff0000, v147
v_mul_f32 v2, s48, v2
v_mul_f32 v3, s48, v3
v_cvt_pk_bf16_f32 v147, v2, v3
s_waitcnt lgkmcnt(2)
v_lshlrev_b32 v2, 16, v148
v_and_b32 v3, 0xffff0000, v148
v_mul_f32 v2, s48, v2
v_mul_f32 v3, s48, v3
v_cvt_pk_bf16_f32 v148, v2, v3
v_lshlrev_b32 v2, 16, v149
v_and_b32 v3, 0xffff0000, v149
v_mul_f32 v2, s48, v2
v_mul_f32 v3, s48, v3
v_cvt_pk_bf16_f32 v149, v2, v3
v_lshlrev_b32 v2, 16, v150
v_and_b32 v3, 0xffff0000, v150
v_mul_f32 v2, s48, v2
v_mul_f32 v3, s48, v3
v_cvt_pk_bf16_f32 v150, v2, v3
v_lshlrev_b32 v2, 16, v151
v_and_b32 v3, 0xffff0000, v151
v_mul_f32 v2, s48, v2
v_mul_f32 v3, s48, v3
v_cvt_pk_bf16_f32 v151, v2, v3
s_waitcnt lgkmcnt(1)
v_lshlrev_b32 v2, 16, v152
v_and_b32 v3, 0xffff0000, v152
v_mul_f32 v2, s48, v2
v_mul_f32 v3, s48, v3
v_cvt_pk_bf16_f32 v152, v2, v3
v_lshlrev_b32 v2, 16, v153
v_and_b32 v3, 0xffff0000, v153
v_mul_f32 v2, s48, v2
v_mul_f32 v3, s48, v3
v_cvt_pk_bf16_f32 v153, v2, v3
v_lshlrev_b32 v2, 16, v154
v_and_b32 v3, 0xffff0000, v154
v_mul_f32 v2, s48, v2
v_mul_f32 v3, s48, v3
v_cvt_pk_bf16_f32 v154, v2, v3
v_lshlrev_b32 v2, 16, v155
v_and_b32 v3, 0xffff0000, v155
v_mul_f32 v2, s48, v2
v_mul_f32 v3, s48, v3
v_cvt_pk_bf16_f32 v155, v2, v3
s_waitcnt lgkmcnt(0)
v_lshlrev_b32 v2, 16, v156
v_and_b32 v3, 0xffff0000, v156
v_mul_f32 v2, s48, v2
v_mul_f32 v3, s48, v3
v_cvt_pk_bf16_f32 v156, v2, v3
v_lshlrev_b32 v2, 16, v157
v_and_b32 v3, 0xffff0000, v157
v_mul_f32 v2, s48, v2
v_mul_f32 v3, s48, v3
v_cvt_pk_bf16_f32 v157, v2, v3
v_lshlrev_b32 v2, 16, v158
v_and_b32 v3, 0xffff0000, v158
v_mul_f32 v2, s48, v2
v_mul_f32 v3, s48, v3
v_cvt_pk_bf16_f32 v158, v2, v3
v_lshlrev_b32 v2, 16, v159
v_and_b32 v3, 0xffff0000, v159
v_mul_f32 v2, s48, v2
v_mul_f32 v3, s48, v3
v_cvt_pk_bf16_f32 v159, v2, v3
ds_read_b128 v[192:195], v8 offset:49152
ds_read_b128 v[196:199], v9 offset:49152
ds_read_b128 v[200:203], v10 offset:49152
ds_read_b128 v[204:207], v11 offset:49152
ds_read_b128 v[208:211], v8 offset:53248
ds_read_b128 v[212:215], v9 offset:53248
ds_read_b128 v[216:219], v10 offset:53248
ds_read_b128 v[220:223], v11 offset:53248
v_mov_b32 v2, 1
v_lshlrev_b32 v3, 8, v1
s_waitcnt lgkmcnt(0)
v_mfma_f32_16x16x32_bf16 v[160:163], v[192:195], v[128:131], 0
v_mfma_f32_16x16x32_bf16 v[164:167], v[192:195], v[144:147], 0
v_mfma_f32_16x16x32_bf16 v[160:163], v[196:199], v[132:135], v[160:163]
v_mfma_f32_16x16x32_bf16 v[164:167], v[196:199], v[148:151], v[164:167]
ds_read_b128 v[192:195], v8 offset:57344
v_mfma_f32_16x16x32_bf16 v[160:163], v[200:203], v[136:139], v[160:163]
v_mfma_f32_16x16x32_bf16 v[164:167], v[200:203], v[152:155], v[164:167]
ds_read_b128 v[196:199], v9 offset:57344
v_mfma_f32_16x16x32_bf16 v[160:163], v[204:207], v[140:143], v[160:163]
v_mfma_f32_16x16x32_bf16 v[164:167], v[204:207], v[156:159], v[164:167]
ds_read_b128 v[200:203], v10 offset:57344
v_mfma_f32_16x16x32_bf16 v[168:171], v[208:211], v[128:131], 0
v_mfma_f32_16x16x32_bf16 v[172:175], v[208:211], v[144:147], 0
ds_read_b128 v[204:207], v11 offset:57344
v_mfma_f32_16x16x32_bf16 v[168:171], v[212:215], v[132:135], v[168:171]
v_mfma_f32_16x16x32_bf16 v[172:175], v[212:215], v[148:151], v[172:175]
ds_read_b128 v[208:211], v8 offset:61440
v_mfma_f32_16x16x32_bf16 v[168:171], v[216:219], v[136:139], v[168:171]
v_mfma_f32_16x16x32_bf16 v[172:175], v[216:219], v[152:155], v[172:175]
ds_read_b128 v[212:215], v9 offset:61440
v_mfma_f32_16x16x32_bf16 v[168:171], v[220:223], v[140:143], v[168:171]
v_mfma_f32_16x16x32_bf16 v[172:175], v[220:223], v[156:159], v[172:175]
ds_read_b128 v[216:219], v10 offset:61440
s_nop 0
ds_read_b128 v[220:223], v11 offset:61440
s_cmp_lg_u32 s59, 0
s_cbranch_scc1 L_nosig
s_waitcnt vmcnt(0)
s_lshl_b32 s52, s61, 2
buffer_store_dword v2, v3, s[36:39], s52 offen sc1
L_nosig:
s_nop 2
v_mov_b32 v3, 0xff7fffff
v_max3_f32 v27, v160, v161, v162
v_max3_f32 v27, v27, v163, v168
v_max3_f32 v27, v27, v169, v170
v_max3_f32 v27, v27, v171, v3
v_max3_f32 v5, v164, v165, v166
v_max3_f32 v5, v5, v167, v172
v_max3_f32 v5, v5, v173, v174
v_max3_f32 v5, v5, v175, v3
v_mov_b32 v2, v27
v_mov_b32 v6, v5
s_nop 1
v_permlane32_swap_b32 v27, v2
v_permlane32_swap_b32 v5, v6
v_max_f32 v27, v27, v2
v_max_f32 v5, v5, v6
v_mov_b32 v2, v27
v_mov_b32 v6, v5
s_nop 1
v_permlane16_swap_b32 v27, v2
v_permlane16_swap_b32 v5, v6
v_max_f32 v27, v27, v2
v_max_f32 v5, v5, v6
v_sub_f32 v32, 0, v27
v_sub_f32 v33, 0, v27
v_sub_f32 v34, 0, v27
v_sub_f32 v35, 0, v27
v_sub_f32 v36, 0, v5
v_sub_f32 v37, 0, v5
v_sub_f32 v38, 0, v5
v_sub_f32 v39, 0, v5
v_sub_f32 v160, v160, v27
v_sub_f32 v161, v161, v27
v_sub_f32 v162, v162, v27
v_sub_f32 v163, v163, v27
v_sub_f32 v164, v164, v5
v_sub_f32 v165, v165, v5
v_sub_f32 v166, v166, v5
v_sub_f32 v167, v167, v5
v_sub_f32 v168, v168, v27
v_sub_f32 v169, v169, v27
v_sub_f32 v170, v170, v27
v_sub_f32 v171, v171, v27
v_sub_f32 v172, v172, v5
v_sub_f32 v173, v173, v5
v_sub_f32 v174, v174, v5
v_sub_f32 v175, v175, v5
.p2align 6
L_loop:
s_waitcnt lgkmcnt(2)
s_barrier
v_mfma_f32_16x16x32_bf16 v[176:179], v[192:195], v[128:131], v[32:35]
ds_read_b64_tr_b16 v[224:225], v12 offset:0
v_exp_f32 v28, v160
v_mfma_f32_16x16x32_bf16 v[180:183], v[192:195], v[144:147], v[36:39]
ds_read_b64_tr_b16 v[226:227], v12 offset:4096
v_exp_f32 v29, v161
v_mfma_f32_16x16x32_bf16 v[176:179], v[196:199], v[132:135], v[176:179]
ds_read_b64_tr_b16 v[228:229], v13 offset:0
v_exp_f32 v30, v162
v_mfma_f32_16x16x32_bf16 v[180:183], v[196:199], v[148:151], v[180:183]
ds_read_b64_tr_b16 v[230:231], v13 offset:4096
v_cvt_pk_bf16_f32 v48, v28, v29
v_mfma_f32_16x16x32_bf16 v[176:179], v[200:203], v[136:139], v[176:179]
ds_read_b64_tr_b16 v[232:233], v14 offset:0
v_exp_f32 v31, v163
v_mfma_f32_16x16x32_bf16 v[180:183], v[200:203], v[152:155], v[180:183]
ds_read_b64_tr_b16 v[234:235], v14 offset:4096
v_exp_f32 v3, v168
v_mfma_f32_16x16x32_bf16 v[176:179], v[204:207], v[140:143], v[176:179]
ds_read_b64_tr_b16 v[236:237], v15 offset:0
v_exp_f32 v4, v169
v_mfma_f32_16x16x32_bf16 v[180:183], v[204:207], v[156:159], v[180:183]
ds_read_b64_tr_b16 v[238:239], v15 offset:4096
v_cvt_pk_bf16_f32 v49, v30, v31
v_mfma_f32_16x16x32_bf16 v[184:187], v[208:211], v[128:131], v[32:35]
ds_read_b64_tr_b16 v[240:241], v16 offset:0
v_exp_f32 v28, v170
v_mfma_f32_16x16x32_bf16 v[188:191], v[208:211], v[144:147], v[36:39]
ds_read_b64_tr_b16 v[242:243], v16 offset:4096
v_exp_f32 v29, v171
v_cvt_pk_bf16_f32 v50, v3, v4
v_mfma_f32_16x16x32_bf16 v[184:187], v[212:215], v[132:135], v[184:187]
ds_read_b64_tr_b16 v[244:245], v17 offset:0
v_exp_f32 v30, v164
v_mfma_f32_16x16x32_bf16 v[188:191], v[212:215], v[148:151], v[188:191]
ds_read_b64_tr_b16 v[246:247], v17 offset:4096
v_cvt_pk_bf16_f32 v51, v28, v29
s_waitcnt lgkmcnt(12)
v_mfma_f32_16x16x32_bf16 v[184:187], v[216:219], v[136:139], v[184:187]
ds_read_b64_tr_b16 v[248:249], v18 offset:0
v_exp_f32 v31, v165
v_mfma_f32_16x16x32_bf16 v[188:191], v[216:219], v[152:155], v[188:191]
ds_read_b64_tr_b16 v[250:251], v18 offset:4096
v_mfma_f32_16x16x32_bf16 v[184:187], v[220:223], v[140:143], v[184:187]
ds_read_b64_tr_b16 v[252:253], v19 offset:0
v_exp_f32 v3, v166
v_mfma_f32_16x16x32_bf16 v[188:191], v[220:223], v[156:159], v[188:191]
ds_read_b64_tr_b16 v[254:255], v19 offset:4096
v_cvt_pk_bf16_f32 v52, v30, v31
v_mfma_f32_16x16x32_bf16 v[40:43], v[20:23], v[48:51], 0
s_waitcnt lgkmcnt(4)
v_mfma_f32_16x16x32_bf16 v[64:67], v[56:59], v[224:227], v[64:67]
ds_read_b128 v[192:195], v8 offset:0
v_exp_f32 v4, v167
v_mfma_f32_16x16x32_bf16 v[80:83], v[60:63], v[224:227], v[80:83]
v_mfma_f32_16x16x32_bf16 v[68:71], v[56:59], v[228:231], v[68:71]
ds_read_b128 v[196:199], v9 offset:0
v_exp_f32 v28, v172
v_mfma_f32_16x16x32_bf16 v[84:87], v[60:63], v[228:231], v[84:87]
v_exp_f32 v29, v173
v_cvt_pk_bf16_f32 v53, v3, v4
v_mfma_f32_16x16x32_bf16 v[72:75], v[56:59], v[232:235], v[72:75]
ds_read_b128 v[200:203], v10 offset:0
v_exp_f32 v30, v174
v_mfma_f32_16x16x32_bf16 v[88:91], v[60:63], v[232:235], v[88:91]
v_cvt_pk_bf16_f32 v54, v28, v29
v_mfma_f32_16x16x32_bf16 v[76:79], v[56:59], v[236:239], v[76:79]
ds_read_b128 v[204:207], v11 offset:0
v_exp_f32 v31, v175
v_mfma_f32_16x16x32_bf16 v[92:95], v[60:63], v[236:239], v[92:95]
v_mfma_f32_16x16x32_bf16 v[96:99], v[56:59], v[240:243], v[96:99]
ds_read_b128 v[208:211], v8 offset:4096
v_cvt_pk_bf16_f32 v55, v30, v31
v_mfma_f32_16x16x32_bf16 v[112:115], v[60:63], v[240:243], v[112:115]
v_mfma_f32_16x16x32_bf16 v[100:103], v[56:59], v[244:247], v[100:103]
ds_read_b128 v[212:215], v9 offset:4096
v_mfma_f32_16x16x32_bf16 v[44:47], v[20:23], v[52:55], 0
v_mfma_f32_16x16x32_bf16 v[116:119], v[60:63], v[244:247], v[116:119]
s_waitcnt lgkmcnt(6)
v_mfma_f32_16x16x32_bf16 v[104:107], v[56:59], v[248:251], v[104:107]
ds_read_b128 v[216:219], v10 offset:4096
v_mfma_f32_16x16x32_bf16 v[120:123], v[60:63], v[248:251], v[120:123]
v_mfma_f32_16x16x32_bf16 v[108:111], v[56:59], v[252:255], v[108:111]
ds_read_b128 v[220:223], v11 offset:4096
v_mfma_f32_16x16x32_bf16 v[124:127], v[60:63], v[252:255], v[124:127]
s_nop 0
v_max_f32 v27, v40, v44
v_cmp_lt_f32 vcc, s49, v27
s_cbranch_vccnz L_rare0
L_ret0:
v_add_f32 v25, v25, v40
v_add_f32 v26, v26, v44
s_waitcnt lgkmcnt(2)
s_barrier
v_mfma_f32_16x16x32_bf16 v[160:163], v[192:195], v[128:131], v[32:35]
ds_read_b64_tr_b16 v[224:225], v12 offset:8192
v_exp_f32 v28, v176
v_mfma_f32_16x16x32_bf16 v[164:167], v[192:195], v[144:147], v[36:39]
ds_read_b64_tr_b16 v[226:227], v12 offset:12288
v_exp_f32 v29, v177
v_mfma_f32_16x16x32_bf16 v[160:163], v[196:199], v[132:135], v[160:163]
ds_read_b64_tr_b16 v[228:229], v13 offset:8192
v_exp_f32 v30, v178
v_mfma_f32_16x16x32_bf16 v[164:167], v[196:199], v[148:151], v[164:167]
ds_read_b64_tr_b16 v[230:231], v13 offset:12288
v_cvt_pk_bf16_f32 v56, v28, v29
v_mfma_f32_16x16x32_bf16 v[160:163], v[200:203], v[136:139], v[160:163]
ds_read_b64_tr_b16 v[232:233], v14 offset:8192
v_exp_f32 v31, v179
v_mfma_f32_16x16x32_bf16 v[164:167], v[200:203], v[152:155], v[164:167]
ds_read_b64_tr_b16 v[234:235], v14 offset:12288
v_exp_f32 v3, v184
v_mfma_f32_16x16x32_bf16 v[160:163], v[204:207], v[140:143], v[160:163]
ds_read_b64_tr_b16 v[236:237], v15 offset:8192
v_exp_f32 v4, v185
v_mfma_f32_16x16x32_bf16 v[164:167], v[204:207], v[156:159], v[164:167]
ds_read_b64_tr_b16 v[238:239], v15 offset:12288
v_cvt_pk_bf16_f32 v57, v30, v31
v_mfma_f32_16x16x32_bf16 v[168:171], v[208:211], v[128:131], v[32:35]
ds_read_b64_tr_b16 v[240:241], v16 offset:8192
v_exp_f32 v28, v186
v_mfma_f32_16x16x32_bf16 v[172:175], v[208:211], v[144:147], v[36:39]
ds_read_b64_tr_b16 v[242:243], v16 offset:12288
v_exp_f32 v29, v187
v_cvt_pk_bf16_f32 v58, v3, v4
v_mfma_f32_16x16x32_bf16 v[168:171], v[212:215], v[132:135], v[168:171]
ds_read_b64_tr_b16 v[244:245], v17 offset:8192
v_exp_f32 v30, v180
v_mfma_f32_16x16x32_bf16 v[172:175], v[212:215], v[148:151], v[172:175]
ds_read_b64_tr_b16 v[246:247], v17 offset:12288
v_cvt_pk_bf16_f32 v59, v28, v29
s_waitcnt lgkmcnt(12)
v_mfma_f32_16x16x32_bf16 v[168:171], v[216:219], v[136:139], v[168:171]
ds_read_b64_tr_b16 v[248:249], v18 offset:8192
v_exp_f32 v31, v181
v_mfma_f32_16x16x32_bf16 v[172:175], v[216:219], v[152:155], v[172:175]
ds_read_b64_tr_b16 v[250:251], v18 offset:12288
v_mfma_f32_16x16x32_bf16 v[168:171], v[220:223], v[140:143], v[168:171]
ds_read_b64_tr_b16 v[252:253], v19 offset:8192
v_exp_f32 v3, v182
v_mfma_f32_16x16x32_bf16 v[172:175], v[220:223], v[156:159], v[172:175]
ds_read_b64_tr_b16 v[254:255], v19 offset:12288
v_cvt_pk_bf16_f32 v60, v30, v31
v_mfma_f32_16x16x32_bf16 v[40:43], v[20:23], v[56:59], 0
s_waitcnt lgkmcnt(4)
v_mfma_f32_16x16x32_bf16 v[64:67], v[48:51], v[224:227], v[64:67]
ds_read_b128 v[192:195], v8 offset:8192
v_exp_f32 v4, v183
v_mfma_f32_16x16x32_bf16 v[80:83], v[52:55], v[224:227], v[80:83]
v_mfma_f32_16x16x32_bf16 v[68:71], v[48:51], v[228:231], v[68:71]
ds_read_b128 v[196:199], v9 offset:8192
v_exp_f32 v28, v188
v_mfma_f32_16x16x32_bf16 v[84:87], v[52:55], v[228:231], v[84:87]
v_exp_f32 v29, v189
v_cvt_pk_bf16_f32 v61, v3, v4
v_mfma_f32_16x16x32_bf16 v[72:75], v[48:51], v[232:235], v[72:75]
ds_read_b128 v[200:203], v10 offset:8192
v_exp_f32 v30, v190
v_mfma_f32_16x16x32_bf16 v[88:91], v[52:55], v[232:235], v[88:91]
v_cvt_pk_bf16_f32 v62, v28, v29
v_mfma_f32_16x16x32_bf16 v[76:79], v[48:51], v[236:239], v[76:79]
ds_read_b128 v[204:207], v11 offset:8192
v_exp_f32 v31, v191
v_mfma_f32_16x16x32_bf16 v[92:95], v[52:55], v[236:239], v[92:95]
v_mfma_f32_16x16x32_bf16 v[96:99], v[48:51], v[240:243], v[96:99]
ds_read_b128 v[208:211], v8 offset:12288
v_cvt_pk_bf16_f32 v63, v30, v31
v_mfma_f32_16x16x32_bf16 v[112:115], v[52:55], v[240:243], v[112:115]
v_mfma_f32_16x16x32_bf16 v[100:103], v[48:51], v[244:247], v[100:103]
ds_read_b128 v[212:215], v9 offset:12288
v_mfma_f32_16x16x32_bf16 v[44:47], v[20:23], v[60:63], 0
v_mfma_f32_16x16x32_bf16 v[116:119], v[52:55], v[244:247], v[116:119]
s_waitcnt lgkmcnt(6)
v_mfma_f32_16x16x32_bf16 v[104:107], v[48:51], v[248:251], v[104:107]
ds_read_b128 v[216:219], v10 offset:12288
v_mfma_f32_16x16x32_bf16 v[120:123], v[52:55], v[248:251], v[120:123]
v_mfma_f32_16x16x32_bf16 v[108:111], v[48:51], v[252:255], v[108:111]
ds_read_b128 v[220:223], v11 offset:12288
v_mfma_f32_16x16x32_bf16 v[124:127], v[52:55], v[252:255], v[124:127]
s_nop 0
v_max_f32 v27, v40, v44
v_cmp_lt_f32 vcc, s49, v27
s_cbranch_vccnz L_rare1
L_ret1:
v_add_f32 v25, v25, v40
v_add_f32 v26, v26, v44
s_waitcnt lgkmcnt(2)
s_barrier
v_mfma_f32_16x16x32_bf16 v[176:179], v[192:195], v[128:131], v[32:35]
ds_read_b64_tr_b16 v[224:225], v12 offset:16384
v_exp_f32 v28, v160
v_mfma_f32_16x16x32_bf16 v[180:183], v[192:195], v[144:147], v[36:39]
ds_read_b64_tr_b16 v[226:227], v12 offset:20480
v_exp_f32 v29, v161
v_mfma_f32_16x16x32_bf16 v[176:179], v[196:199], v[132:135], v[176:179]
ds_read_b64_tr_b16 v[228:229], v13 offset:16384
v_exp_f32 v30, v162
v_mfma_f32_16x16x32_bf16 v[180:183], v[196:199], v[148:151], v[180:183]
ds_read_b64_tr_b16 v[230:231], v13 offset:20480
v_cvt_pk_bf16_f32 v48, v28, v29
v_mfma_f32_16x16x32_bf16 v[176:179], v[200:203], v[136:139], v[176:179]
ds_read_b64_tr_b16 v[232:233], v14 offset:16384
v_exp_f32 v31, v163
v_mfma_f32_16x16x32_bf16 v[180:183], v[200:203], v[152:155], v[180:183]
ds_read_b64_tr_b16 v[234:235], v14 offset:20480
v_exp_f32 v3, v168
v_mfma_f32_16x16x32_bf16 v[176:179], v[204:207], v[140:143], v[176:179]
ds_read_b64_tr_b16 v[236:237], v15 offset:16384
v_exp_f32 v4, v169
v_mfma_f32_16x16x32_bf16 v[180:183], v[204:207], v[156:159], v[180:183]
ds_read_b64_tr_b16 v[238:239], v15 offset:20480
v_cvt_pk_bf16_f32 v49, v30, v31
v_mfma_f32_16x16x32_bf16 v[184:187], v[208:211], v[128:131], v[32:35]
ds_read_b64_tr_b16 v[240:241], v16 offset:16384
v_exp_f32 v28, v170
v_mfma_f32_16x16x32_bf16 v[188:191], v[208:211], v[144:147], v[36:39]
ds_read_b64_tr_b16 v[242:243], v16 offset:20480
v_exp_f32 v29, v171
v_cvt_pk_bf16_f32 v50, v3, v4
v_mfma_f32_16x16x32_bf16 v[184:187], v[212:215], v[132:135], v[184:187]
ds_read_b64_tr_b16 v[244:245], v17 offset:16384
v_exp_f32 v30, v164
v_mfma_f32_16x16x32_bf16 v[188:191], v[212:215], v[148:151], v[188:191]
ds_read_b64_tr_b16 v[246:247], v17 offset:20480
v_cvt_pk_bf16_f32 v51, v28, v29
s_waitcnt lgkmcnt(12)
v_mfma_f32_16x16x32_bf16 v[184:187], v[216:219], v[136:139], v[184:187]
ds_read_b64_tr_b16 v[248:249], v18 offset:16384
v_exp_f32 v31, v165
v_mfma_f32_16x16x32_bf16 v[188:191], v[216:219], v[152:155], v[188:191]
ds_read_b64_tr_b16 v[250:251], v18 offset:20480
v_mfma_f32_16x16x32_bf16 v[184:187], v[220:223], v[140:143], v[184:187]
ds_read_b64_tr_b16 v[252:253], v19 offset:16384
v_exp_f32 v3, v166
v_mfma_f32_16x16x32_bf16 v[188:191], v[220:223], v[156:159], v[188:191]
ds_read_b64_tr_b16 v[254:255], v19 offset:20480
v_cvt_pk_bf16_f32 v52, v30, v31
v_mfma_f32_16x16x32_bf16 v[40:43], v[20:23], v[48:51], 0
s_waitcnt lgkmcnt(4)
v_mfma_f32_16x16x32_bf16 v[64:67], v[56:59], v[224:227], v[64:67]
ds_read_b128 v[192:195], v8 offset:16384
v_exp_f32 v4, v167
v_mfma_f32_16x16x32_bf16 v[80:83], v[60:63], v[224:227], v[80:83]
v_mfma_f32_16x16x32_bf16 v[68:71], v[56:59], v[228:231], v[68:71]
ds_read_b128 v[196:199], v9 offset:16384
v_exp_f32 v28, v172
v_mfma_f32_16x16x32_bf16 v[84:87], v[60:63], v[228:231], v[84:87]
v_exp_f32 v29, v173
v_cvt_pk_bf16_f32 v53, v3, v4
v_mfma_f32_16x16x32_bf16 v[72:75], v[56:59], v[232:235], v[72:75]
ds_read_b128 v[200:203], v10 offset:16384
v_exp_f32 v30, v174
v_mfma_f32_16x16x32_bf16 v[88:91], v[60:63], v[232:235], v[88:91]
v_cvt_pk_bf16_f32 v54, v28, v29
v_mfma_f32_16x16x32_bf16 v[76:79], v[56:59], v[236:239], v[76:79]
ds_read_b128 v[204:207], v11 offset:16384
v_exp_f32 v31, v175
v_mfma_f32_16x16x32_bf16 v[92:95], v[60:63], v[236:239], v[92:95]
v_mfma_f32_16x16x32_bf16 v[96:99], v[56:59], v[240:243], v[96:99]
ds_read_b128 v[208:211], v8 offset:20480
v_cvt_pk_bf16_f32 v55, v30, v31
v_mfma_f32_16x16x32_bf16 v[112:115], v[60:63], v[240:243], v[112:115]
v_mfma_f32_16x16x32_bf16 v[100:103], v[56:59], v[244:247], v[100:103]
ds_read_b128 v[212:215], v9 offset:20480
v_mfma_f32_16x16x32_bf16 v[44:47], v[20:23], v[52:55], 0
v_mfma_f32_16x16x32_bf16 v[116:119], v[60:63], v[244:247], v[116:119]
s_waitcnt lgkmcnt(6)
v_mfma_f32_16x16x32_bf16 v[104:107], v[56:59], v[248:251], v[104:107]
ds_read_b128 v[216:219], v10 offset:20480
v_mfma_f32_16x16x32_bf16 v[120:123], v[60:63], v[248:251], v[120:123]
v_mfma_f32_16x16x32_bf16 v[108:111], v[56:59], v[252:255], v[108:111]
ds_read_b128 v[220:223], v11 offset:20480
v_mfma_f32_16x16x32_bf16 v[124:127], v[60:63], v[252:255], v[124:127]
s_nop 0
v_max_f32 v27, v40, v44
v_cmp_lt_f32 vcc, s49, v27
s_cbranch_vccnz L_rare2
L_ret2:
v_add_f32 v25, v25, v40
v_add_f32 v26, v26, v44
s_waitcnt lgkmcnt(2)
s_barrier
v_mfma_f32_16x16x32_bf16 v[160:163], v[192:195], v[128:131], v[32:35]
ds_read_b64_tr_b16 v[224:225], v12 offset:24576
v_exp_f32 v28, v176
v_mfma_f32_16x16x32_bf16 v[164:167], v[192:195], v[144:147], v[36:39]
ds_read_b64_tr_b16 v[226:227], v12 offset:28672
v_exp_f32 v29, v177
v_mfma_f32_16x16x32_bf16 v[160:163], v[196:199], v[132:135], v[160:163]
ds_read_b64_tr_b16 v[228:229], v13 offset:24576
v_exp_f32 v30, v178
v_mfma_f32_16x16x32_bf16 v[164:167], v[196:199], v[148:151], v[164:167]
ds_read_b64_tr_b16 v[230:231], v13 offset:28672
v_cvt_pk_bf16_f32 v56, v28, v29
v_mfma_f32_16x16x32_bf16 v[160:163], v[200:203], v[136:139], v[160:163]
ds_read_b64_tr_b16 v[232:233], v14 offset:24576
v_exp_f32 v31, v179
v_mfma_f32_16x16x32_bf16 v[164:167], v[200:203], v[152:155], v[164:167]
ds_read_b64_tr_b16 v[234:235], v14 offset:28672
v_exp_f32 v3, v184
v_mfma_f32_16x16x32_bf16 v[160:163], v[204:207], v[140:143], v[160:163]
ds_read_b64_tr_b16 v[236:237], v15 offset:24576
v_exp_f32 v4, v185
v_mfma_f32_16x16x32_bf16 v[164:167], v[204:207], v[156:159], v[164:167]
ds_read_b64_tr_b16 v[238:239], v15 offset:28672
v_cvt_pk_bf16_f32 v57, v30, v31
v_mfma_f32_16x16x32_bf16 v[168:171], v[208:211], v[128:131], v[32:35]
ds_read_b64_tr_b16 v[240:241], v16 offset:24576
v_exp_f32 v28, v186
v_mfma_f32_16x16x32_bf16 v[172:175], v[208:211], v[144:147], v[36:39]
ds_read_b64_tr_b16 v[242:243], v16 offset:28672
v_exp_f32 v29, v187
v_cvt_pk_bf16_f32 v58, v3, v4
v_mfma_f32_16x16x32_bf16 v[168:171], v[212:215], v[132:135], v[168:171]
ds_read_b64_tr_b16 v[244:245], v17 offset:24576
v_exp_f32 v30, v180
v_mfma_f32_16x16x32_bf16 v[172:175], v[212:215], v[148:151], v[172:175]
ds_read_b64_tr_b16 v[246:247], v17 offset:28672
v_cvt_pk_bf16_f32 v59, v28, v29
s_waitcnt lgkmcnt(12)
v_mfma_f32_16x16x32_bf16 v[168:171], v[216:219], v[136:139], v[168:171]
ds_read_b64_tr_b16 v[248:249], v18 offset:24576
v_exp_f32 v31, v181
v_mfma_f32_16x16x32_bf16 v[172:175], v[216:219], v[152:155], v[172:175]
ds_read_b64_tr_b16 v[250:251], v18 offset:28672
v_mfma_f32_16x16x32_bf16 v[168:171], v[220:223], v[140:143], v[168:171]
ds_read_b64_tr_b16 v[252:253], v19 offset:24576
v_exp_f32 v3, v182
v_mfma_f32_16x16x32_bf16 v[172:175], v[220:223], v[156:159], v[172:175]
ds_read_b64_tr_b16 v[254:255], v19 offset:28672
v_cvt_pk_bf16_f32 v60, v30, v31
v_mfma_f32_16x16x32_bf16 v[40:43], v[20:23], v[56:59], 0
s_waitcnt lgkmcnt(4)
v_mfma_f32_16x16x32_bf16 v[64:67], v[48:51], v[224:227], v[64:67]
ds_read_b128 v[192:195], v8 offset:24576
v_exp_f32 v4, v183
v_mfma_f32_16x16x32_bf16 v[80:83], v[52:55], v[224:227], v[80:83]
v_mfma_f32_16x16x32_bf16 v[68:71], v[48:51], v[228:231], v[68:71]
ds_read_b128 v[196:199], v9 offset:24576
v_exp_f32 v28, v188
v_mfma_f32_16x16x32_bf16 v[84:87], v[52:55], v[228:231], v[84:87]
v_exp_f32 v29, v189
v_cvt_pk_bf16_f32 v61, v3, v4
v_mfma_f32_16x16x32_bf16 v[72:75], v[48:51], v[232:235], v[72:75]
ds_read_b128 v[200:203], v10 offset:24576
v_exp_f32 v30, v190
v_mfma_f32_16x16x32_bf16 v[88:91], v[52:55], v[232:235], v[88:91]
v_cvt_pk_bf16_f32 v62, v28, v29
v_mfma_f32_16x16x32_bf16 v[76:79], v[48:51], v[236:239], v[76:79]
ds_read_b128 v[204:207], v11 offset:24576
v_exp_f32 v31, v191
v_mfma_f32_16x16x32_bf16 v[92:95], v[52:55], v[236:239], v[92:95]
v_mfma_f32_16x16x32_bf16 v[96:99], v[48:51], v[240:243], v[96:99]
ds_read_b128 v[208:211], v8 offset:28672
v_cvt_pk_bf16_f32 v63, v30, v31
v_mfma_f32_16x16x32_bf16 v[112:115], v[52:55], v[240:243], v[112:115]
v_mfma_f32_16x16x32_bf16 v[100:103], v[48:51], v[244:247], v[100:103]
ds_read_b128 v[212:215], v9 offset:28672
v_mfma_f32_16x16x32_bf16 v[44:47], v[20:23], v[60:63], 0
v_mfma_f32_16x16x32_bf16 v[116:119], v[52:55], v[244:247], v[116:119]
s_waitcnt lgkmcnt(6)
v_mfma_f32_16x16x32_bf16 v[104:107], v[48:51], v[248:251], v[104:107]
ds_read_b128 v[216:219], v10 offset:28672
v_mfma_f32_16x16x32_bf16 v[120:123], v[52:55], v[248:251], v[120:123]
v_mfma_f32_16x16x32_bf16 v[108:111], v[48:51], v[252:255], v[108:111]
ds_read_b128 v[220:223], v11 offset:28672
v_mfma_f32_16x16x32_bf16 v[124:127], v[52:55], v[252:255], v[124:127]
s_nop 0
v_max_f32 v27, v40, v44
v_cmp_lt_f32 vcc, s49, v27
s_cbranch_vccnz L_rare3
L_ret3:
v_add_f32 v25, v25, v40
v_add_f32 v26, v26, v44
s_waitcnt lgkmcnt(2)
s_barrier
v_mfma_f32_16x16x32_bf16 v[176:179], v[192:195], v[128:131], v[32:35]
ds_read_b64_tr_b16 v[224:225], v12 offset:32768
v_exp_f32 v28, v160
v_mfma_f32_16x16x32_bf16 v[180:183], v[192:195], v[144:147], v[36:39]
ds_read_b64_tr_b16 v[226:227], v12 offset:36864
v_exp_f32 v29, v161
v_mfma_f32_16x16x32_bf16 v[176:179], v[196:199], v[132:135], v[176:179]
ds_read_b64_tr_b16 v[228:229], v13 offset:32768
v_exp_f32 v30, v162
v_mfma_f32_16x16x32_bf16 v[180:183], v[196:199], v[148:151], v[180:183]
ds_read_b64_tr_b16 v[230:231], v13 offset:36864
v_cvt_pk_bf16_f32 v48, v28, v29
v_mfma_f32_16x16x32_bf16 v[176:179], v[200:203], v[136:139], v[176:179]
ds_read_b64_tr_b16 v[232:233], v14 offset:32768
v_exp_f32 v31, v163
v_mfma_f32_16x16x32_bf16 v[180:183], v[200:203], v[152:155], v[180:183]
ds_read_b64_tr_b16 v[234:235], v14 offset:36864
v_exp_f32 v3, v168
v_mfma_f32_16x16x32_bf16 v[176:179], v[204:207], v[140:143], v[176:179]
ds_read_b64_tr_b16 v[236:237], v15 offset:32768
v_exp_f32 v4, v169
v_mfma_f32_16x16x32_bf16 v[180:183], v[204:207], v[156:159], v[180:183]
ds_read_b64_tr_b16 v[238:239], v15 offset:36864
v_cvt_pk_bf16_f32 v49, v30, v31
v_mfma_f32_16x16x32_bf16 v[184:187], v[208:211], v[128:131], v[32:35]
ds_read_b64_tr_b16 v[240:241], v16 offset:32768
v_exp_f32 v28, v170
v_mfma_f32_16x16x32_bf16 v[188:191], v[208:211], v[144:147], v[36:39]
ds_read_b64_tr_b16 v[242:243], v16 offset:36864
v_exp_f32 v29, v171
v_cvt_pk_bf16_f32 v50, v3, v4
v_mfma_f32_16x16x32_bf16 v[184:187], v[212:215], v[132:135], v[184:187]
ds_read_b64_tr_b16 v[244:245], v17 offset:32768
v_exp_f32 v30, v164
v_mfma_f32_16x16x32_bf16 v[188:191], v[212:215], v[148:151], v[188:191]
ds_read_b64_tr_b16 v[246:247], v17 offset:36864
v_cvt_pk_bf16_f32 v51, v28, v29
s_waitcnt lgkmcnt(12)
v_mfma_f32_16x16x32_bf16 v[184:187], v[216:219], v[136:139], v[184:187]
ds_read_b64_tr_b16 v[248:249], v18 offset:32768
v_exp_f32 v31, v165
v_mfma_f32_16x16x32_bf16 v[188:191], v[216:219], v[152:155], v[188:191]
ds_read_b64_tr_b16 v[250:251], v18 offset:36864
v_mfma_f32_16x16x32_bf16 v[184:187], v[220:223], v[140:143], v[184:187]
ds_read_b64_tr_b16 v[252:253], v19 offset:32768
v_exp_f32 v3, v166
v_mfma_f32_16x16x32_bf16 v[188:191], v[220:223], v[156:159], v[188:191]
ds_read_b64_tr_b16 v[254:255], v19 offset:36864
v_cvt_pk_bf16_f32 v52, v30, v31
v_mfma_f32_16x16x32_bf16 v[40:43], v[20:23], v[48:51], 0
s_waitcnt lgkmcnt(4)
v_mfma_f32_16x16x32_bf16 v[64:67], v[56:59], v[224:227], v[64:67]
ds_read_b128 v[192:195], v8 offset:32768
v_exp_f32 v4, v167
v_mfma_f32_16x16x32_bf16 v[80:83], v[60:63], v[224:227], v[80:83]
v_mfma_f32_16x16x32_bf16 v[68:71], v[56:59], v[228:231], v[68:71]
ds_read_b128 v[196:199], v9 offset:32768
v_exp_f32 v28, v172
v_mfma_f32_16x16x32_bf16 v[84:87], v[60:63], v[228:231], v[84:87]
v_exp_f32 v29, v173
v_cvt_pk_bf16_f32 v53, v3, v4
v_mfma_f32_16x16x32_bf16 v[72:75], v[56:59], v[232:235], v[72:75]
ds_read_b128 v[200:203], v10 offset:32768
v_exp_f32 v30, v174
v_mfma_f32_16x16x32_bf16 v[88:91], v[60:63], v[232:235], v[88:91]
v_cvt_pk_bf16_f32 v54, v28, v29
v_mfma_f32_16x16x32_bf16 v[76:79], v[56:59], v[236:239], v[76:79]
ds_read_b128 v[204:207], v11 offset:32768
v_exp_f32 v31, v175
v_mfma_f32_16x16x32_bf16 v[92:95], v[60:63], v[236:239], v[92:95]
v_mfma_f32_16x16x32_bf16 v[96:99], v[56:59], v[240:243], v[96:99]
ds_read_b128 v[208:211], v8 offset:36864
v_cvt_pk_bf16_f32 v55, v30, v31
v_mfma_f32_16x16x32_bf16 v[112:115], v[60:63], v[240:243], v[112:115]
v_mfma_f32_16x16x32_bf16 v[100:103], v[56:59], v[244:247], v[100:103]
ds_read_b128 v[212:215], v9 offset:36864
v_mfma_f32_16x16x32_bf16 v[44:47], v[20:23], v[52:55], 0
v_mfma_f32_16x16x32_bf16 v[116:119], v[60:63], v[244:247], v[116:119]
s_waitcnt lgkmcnt(6)
v_mfma_f32_16x16x32_bf16 v[104:107], v[56:59], v[248:251], v[104:107]
ds_read_b128 v[216:219], v10 offset:36864
v_mfma_f32_16x16x32_bf16 v[120:123], v[60:63], v[248:251], v[120:123]
v_mfma_f32_16x16x32_bf16 v[108:111], v[56:59], v[252:255], v[108:111]
ds_read_b128 v[220:223], v11 offset:36864
v_mfma_f32_16x16x32_bf16 v[124:127], v[60:63], v[252:255], v[124:127]
s_nop 0
v_max_f32 v27, v40, v44
v_cmp_lt_f32 vcc, s49, v27
s_cbranch_vccnz L_rare4
L_ret4:
v_add_f32 v25, v25, v40
v_add_f32 v26, v26, v44
s_waitcnt lgkmcnt(2)
s_barrier
v_mfma_f32_16x16x32_bf16 v[160:163], v[192:195], v[128:131], v[32:35]
ds_read_b64_tr_b16 v[224:225], v12 offset:40960
v_exp_f32 v28, v176
v_mfma_f32_16x16x32_bf16 v[164:167], v[192:195], v[144:147], v[36:39]
ds_read_b64_tr_b16 v[226:227], v12 offset:45056
v_exp_f32 v29, v177
v_mfma_f32_16x16x32_bf16 v[160:163], v[196:199], v[132:135], v[160:163]
ds_read_b64_tr_b16 v[228:229], v13 offset:40960
v_exp_f32 v30, v178
v_mfma_f32_16x16x32_bf16 v[164:167], v[196:199], v[148:151], v[164:167]
ds_read_b64_tr_b16 v[230:231], v13 offset:45056
v_cvt_pk_bf16_f32 v56, v28, v29
v_mfma_f32_16x16x32_bf16 v[160:163], v[200:203], v[136:139], v[160:163]
ds_read_b64_tr_b16 v[232:233], v14 offset:40960
v_exp_f32 v31, v179
v_mfma_f32_16x16x32_bf16 v[164:167], v[200:203], v[152:155], v[164:167]
ds_read_b64_tr_b16 v[234:235], v14 offset:45056
v_exp_f32 v3, v184
v_mfma_f32_16x16x32_bf16 v[160:163], v[204:207], v[140:143], v[160:163]
ds_read_b64_tr_b16 v[236:237], v15 offset:40960
v_exp_f32 v4, v185
v_mfma_f32_16x16x32_bf16 v[164:167], v[204:207], v[156:159], v[164:167]
ds_read_b64_tr_b16 v[238:239], v15 offset:45056
v_cvt_pk_bf16_f32 v57, v30, v31
v_mfma_f32_16x16x32_bf16 v[168:171], v[208:211], v[128:131], v[32:35]
ds_read_b64_tr_b16 v[240:241], v16 offset:40960
v_exp_f32 v28, v186
v_mfma_f32_16x16x32_bf16 v[172:175], v[208:211], v[144:147], v[36:39]
ds_read_b64_tr_b16 v[242:243], v16 offset:45056
v_exp_f32 v29, v187
v_cvt_pk_bf16_f32 v58, v3, v4
v_mfma_f32_16x16x32_bf16 v[168:171], v[212:215], v[132:135], v[168:171]
ds_read_b64_tr_b16 v[244:245], v17 offset:40960
v_exp_f32 v30, v180
v_mfma_f32_16x16x32_bf16 v[172:175], v[212:215], v[148:151], v[172:175]
ds_read_b64_tr_b16 v[246:247], v17 offset:45056
v_cvt_pk_bf16_f32 v59, v28, v29
s_waitcnt lgkmcnt(12)
v_mfma_f32_16x16x32_bf16 v[168:171], v[216:219], v[136:139], v[168:171]
ds_read_b64_tr_b16 v[248:249], v18 offset:40960
v_exp_f32 v31, v181
v_mfma_f32_16x16x32_bf16 v[172:175], v[216:219], v[152:155], v[172:175]
ds_read_b64_tr_b16 v[250:251], v18 offset:45056
v_mfma_f32_16x16x32_bf16 v[168:171], v[220:223], v[140:143], v[168:171]
ds_read_b64_tr_b16 v[252:253], v19 offset:40960
v_exp_f32 v3, v182
v_mfma_f32_16x16x32_bf16 v[172:175], v[220:223], v[156:159], v[172:175]
ds_read_b64_tr_b16 v[254:255], v19 offset:45056
v_cvt_pk_bf16_f32 v60, v30, v31
v_mfma_f32_16x16x32_bf16 v[40:43], v[20:23], v[56:59], 0
s_waitcnt lgkmcnt(4)
v_mfma_f32_16x16x32_bf16 v[64:67], v[48:51], v[224:227], v[64:67]
ds_read_b128 v[192:195], v8 offset:40960
v_exp_f32 v4, v183
v_mfma_f32_16x16x32_bf16 v[80:83], v[52:55], v[224:227], v[80:83]
v_mfma_f32_16x16x32_bf16 v[68:71], v[48:51], v[228:231], v[68:71]
ds_read_b128 v[196:199], v9 offset:40960
v_exp_f32 v28, v188
v_mfma_f32_16x16x32_bf16 v[84:87], v[52:55], v[228:231], v[84:87]
v_exp_f32 v29, v189
v_cvt_pk_bf16_f32 v61, v3, v4
v_mfma_f32_16x16x32_bf16 v[72:75], v[48:51], v[232:235], v[72:75]
ds_read_b128 v[200:203], v10 offset:40960
v_exp_f32 v30, v190
v_mfma_f32_16x16x32_bf16 v[88:91], v[52:55], v[232:235], v[88:91]
v_cvt_pk_bf16_f32 v62, v28, v29
v_mfma_f32_16x16x32_bf16 v[76:79], v[48:51], v[236:239], v[76:79]
ds_read_b128 v[204:207], v11 offset:40960
v_exp_f32 v31, v191
v_mfma_f32_16x16x32_bf16 v[92:95], v[52:55], v[236:239], v[92:95]
v_mfma_f32_16x16x32_bf16 v[96:99], v[48:51], v[240:243], v[96:99]
ds_read_b128 v[208:211], v8 offset:45056
v_cvt_pk_bf16_f32 v63, v30, v31
v_mfma_f32_16x16x32_bf16 v[112:115], v[52:55], v[240:243], v[112:115]
v_mfma_f32_16x16x32_bf16 v[100:103], v[48:51], v[244:247], v[100:103]
ds_read_b128 v[212:215], v9 offset:45056
v_mfma_f32_16x16x32_bf16 v[44:47], v[20:23], v[60:63], 0
v_mfma_f32_16x16x32_bf16 v[116:119], v[52:55], v[244:247], v[116:119]
s_waitcnt lgkmcnt(6)
v_mfma_f32_16x16x32_bf16 v[104:107], v[48:51], v[248:251], v[104:107]
ds_read_b128 v[216:219], v10 offset:45056
v_mfma_f32_16x16x32_bf16 v[120:123], v[52:55], v[248:251], v[120:123]
v_mfma_f32_16x16x32_bf16 v[108:111], v[48:51], v[252:255], v[108:111]
ds_read_b128 v[220:223], v11 offset:45056
v_mfma_f32_16x16x32_bf16 v[124:127], v[52:55], v[252:255], v[124:127]
s_nop 0
v_max_f32 v27, v40, v44
v_cmp_lt_f32 vcc, s49, v27
s_cbranch_vccnz L_rare5
L_ret5:
v_add_f32 v25, v25, v40
v_add_f32 v26, v26, v44
s_waitcnt lgkmcnt(2)
s_barrier
v_mfma_f32_16x16x32_bf16 v[176:179], v[192:195], v[128:131], v[32:35]
ds_read_b64_tr_b16 v[224:225], v12 offset:49152
v_exp_f32 v28, v160
v_mfma_f32_16x16x32_bf16 v[180:183], v[192:195], v[144:147], v[36:39]
ds_read_b64_tr_b16 v[226:227], v12 offset:53248
v_exp_f32 v29, v161
v_mfma_f32_16x16x32_bf16 v[176:179], v[196:199], v[132:135], v[176:179]
ds_read_b64_tr_b16 v[228:229], v13 offset:49152
v_exp_f32 v30, v162
v_mfma_f32_16x16x32_bf16 v[180:183], v[196:199], v[148:151], v[180:183]
ds_read_b64_tr_b16 v[230:231], v13 offset:53248
v_cvt_pk_bf16_f32 v48, v28, v29
v_mfma_f32_16x16x32_bf16 v[176:179], v[200:203], v[136:139], v[176:179]
ds_read_b64_tr_b16 v[232:233], v14 offset:49152
v_exp_f32 v31, v163
v_mfma_f32_16x16x32_bf16 v[180:183], v[200:203], v[152:155], v[180:183]
ds_read_b64_tr_b16 v[234:235], v14 offset:53248
v_exp_f32 v3, v168
v_mfma_f32_16x16x32_bf16 v[176:179], v[204:207], v[140:143], v[176:179]
ds_read_b64_tr_b16 v[236:237], v15 offset:49152
v_exp_f32 v4, v169
v_mfma_f32_16x16x32_bf16 v[180:183], v[204:207], v[156:159], v[180:183]
ds_read_b64_tr_b16 v[238:239], v15 offset:53248
v_cvt_pk_bf16_f32 v49, v30, v31
v_mfma_f32_16x16x32_bf16 v[184:187], v[208:211], v[128:131], v[32:35]
ds_read_b64_tr_b16 v[240:241], v16 offset:49152
v_exp_f32 v28, v170
v_mfma_f32_16x16x32_bf16 v[188:191], v[208:211], v[144:147], v[36:39]
ds_read_b64_tr_b16 v[242:243], v16 offset:53248
v_exp_f32 v29, v171
v_cvt_pk_bf16_f32 v50, v3, v4
v_mfma_f32_16x16x32_bf16 v[184:187], v[212:215], v[132:135], v[184:187]
ds_read_b64_tr_b16 v[244:245], v17 offset:49152
v_exp_f32 v30, v164
v_mfma_f32_16x16x32_bf16 v[188:191], v[212:215], v[148:151], v[188:191]
ds_read_b64_tr_b16 v[246:247], v17 offset:53248
v_cvt_pk_bf16_f32 v51, v28, v29
s_waitcnt lgkmcnt(12)
v_mfma_f32_16x16x32_bf16 v[184:187], v[216:219], v[136:139], v[184:187]
ds_read_b64_tr_b16 v[248:249], v18 offset:49152
v_exp_f32 v31, v165
v_mfma_f32_16x16x32_bf16 v[188:191], v[216:219], v[152:155], v[188:191]
ds_read_b64_tr_b16 v[250:251], v18 offset:53248
v_mfma_f32_16x16x32_bf16 v[184:187], v[220:223], v[140:143], v[184:187]
ds_read_b64_tr_b16 v[252:253], v19 offset:49152
v_exp_f32 v3, v166
v_mfma_f32_16x16x32_bf16 v[188:191], v[220:223], v[156:159], v[188:191]
ds_read_b64_tr_b16 v[254:255], v19 offset:53248
v_cvt_pk_bf16_f32 v52, v30, v31
v_mfma_f32_16x16x32_bf16 v[40:43], v[20:23], v[48:51], 0
s_waitcnt lgkmcnt(4)
v_mfma_f32_16x16x32_bf16 v[64:67], v[56:59], v[224:227], v[64:67]
ds_read_b128 v[192:195], v8 offset:49152
v_exp_f32 v4, v167
v_mfma_f32_16x16x32_bf16 v[80:83], v[60:63], v[224:227], v[80:83]
v_mfma_f32_16x16x32_bf16 v[68:71], v[56:59], v[228:231], v[68:71]
ds_read_b128 v[196:199], v9 offset:49152
v_exp_f32 v28, v172
v_mfma_f32_16x16x32_bf16 v[84:87], v[60:63], v[228:231], v[84:87]
v_exp_f32 v29, v173
v_cvt_pk_bf16_f32 v53, v3, v4
v_mfma_f32_16x16x32_bf16 v[72:75], v[56:59], v[232:235], v[72:75]
ds_read_b128 v[200:203], v10 offset:49152
v_exp_f32 v30, v174
v_mfma_f32_16x16x32_bf16 v[88:91], v[60:63], v[232:235], v[88:91]
v_cvt_pk_bf16_f32 v54, v28, v29
v_mfma_f32_16x16x32_bf16 v[76:79], v[56:59], v[236:239], v[76:79]
ds_read_b128 v[204:207], v11 offset:49152
v_exp_f32 v31, v175
v_mfma_f32_16x16x32_bf16 v[92:95], v[60:63], v[236:239], v[92:95]
v_mfma_f32_16x16x32_bf16 v[96:99], v[56:59], v[240:243], v[96:99]
ds_read_b128 v[208:211], v8 offset:53248
v_cvt_pk_bf16_f32 v55, v30, v31
v_mfma_f32_16x16x32_bf16 v[112:115], v[60:63], v[240:243], v[112:115]
s_add_u32 s47, s47, 8
v_mfma_f32_16x16x32_bf16 v[100:103], v[56:59], v[244:247], v[100:103]
ds_read_b128 v[212:215], v9 offset:53248
v_mfma_f32_16x16x32_bf16 v[44:47], v[20:23], v[52:55], 0
v_mfma_f32_16x16x32_bf16 v[116:119], v[60:63], v[244:247], v[116:119]
s_waitcnt lgkmcnt(6)
v_mfma_f32_16x16x32_bf16 v[104:107], v[56:59], v[248:251], v[104:107]
ds_read_b128 v[216:219], v10 offset:53248
s_cmp_lt_u32 s47, 64
v_mfma_f32_16x16x32_bf16 v[120:123], v[60:63], v[248:251], v[120:123]
v_mfma_f32_16x16x32_bf16 v[108:111], v[56:59], v[252:255], v[108:111]
ds_read_b128 v[220:223], v11 offset:53248
v_mfma_f32_16x16x32_bf16 v[124:127], v[60:63], v[252:255], v[124:127]
v_max_f32 v27, v40, v44
v_cmp_lt_f32 vcc, s49, v27
s_cbranch_vccnz L_rare6
L_ret6:
v_add_f32 v25, v25, v40
v_add_f32 v26, v26, v44
s_cbranch_scc0 L_last
s_waitcnt lgkmcnt(2)
s_barrier
v_mfma_f32_16x16x32_bf16 v[160:163], v[192:195], v[128:131], v[32:35]
ds_read_b64_tr_b16 v[224:225], v12 offset:57344
v_exp_f32 v28, v176
v_mfma_f32_16x16x32_bf16 v[164:167], v[192:195], v[144:147], v[36:39]
ds_read_b64_tr_b16 v[226:227], v12 offset:61440
v_exp_f32 v29, v177
v_mfma_f32_16x16x32_bf16 v[160:163], v[196:199], v[132:135], v[160:163]
ds_read_b64_tr_b16 v[228:229], v13 offset:57344
v_exp_f32 v30, v178
v_mfma_f32_16x16x32_bf16 v[164:167], v[196:199], v[148:151], v[164:167]
ds_read_b64_tr_b16 v[230:231], v13 offset:61440
v_cvt_pk_bf16_f32 v56, v28, v29
v_mfma_f32_16x16x32_bf16 v[160:163], v[200:203], v[136:139], v[160:163]
ds_read_b64_tr_b16 v[232:233], v14 offset:57344
v_exp_f32 v31, v179
v_mfma_f32_16x16x32_bf16 v[164:167], v[200:203], v[152:155], v[164:167]
ds_read_b64_tr_b16 v[234:235], v14 offset:61440
v_exp_f32 v3, v184
v_mfma_f32_16x16x32_bf16 v[160:163], v[204:207], v[140:143], v[160:163]
ds_read_b64_tr_b16 v[236:237], v15 offset:57344
v_exp_f32 v4, v185
v_mfma_f32_16x16x32_bf16 v[164:167], v[204:207], v[156:159], v[164:167]
ds_read_b64_tr_b16 v[238:239], v15 offset:61440
v_cvt_pk_bf16_f32 v57, v30, v31
v_mfma_f32_16x16x32_bf16 v[168:171], v[208:211], v[128:131], v[32:35]
ds_read_b64_tr_b16 v[240:241], v16 offset:57344
v_exp_f32 v28, v186
v_mfma_f32_16x16x32_bf16 v[172:175], v[208:211], v[144:147], v[36:39]
ds_read_b64_tr_b16 v[242:243], v16 offset:61440
v_exp_f32 v29, v187
v_cvt_pk_bf16_f32 v58, v3, v4
v_mfma_f32_16x16x32_bf16 v[168:171], v[212:215], v[132:135], v[168:171]
ds_read_b64_tr_b16 v[244:245], v17 offset:57344
v_exp_f32 v30, v180
v_mfma_f32_16x16x32_bf16 v[172:175], v[212:215], v[148:151], v[172:175]
ds_read_b64_tr_b16 v[246:247], v17 offset:61440
v_cvt_pk_bf16_f32 v59, v28, v29
s_waitcnt lgkmcnt(12)
v_mfma_f32_16x16x32_bf16 v[168:171], v[216:219], v[136:139], v[168:171]
ds_read_b64_tr_b16 v[248:249], v18 offset:57344
v_exp_f32 v31, v181
v_mfma_f32_16x16x32_bf16 v[172:175], v[216:219], v[152:155], v[172:175]
ds_read_b64_tr_b16 v[250:251], v18 offset:61440
v_mfma_f32_16x16x32_bf16 v[168:171], v[220:223], v[140:143], v[168:171]
ds_read_b64_tr_b16 v[252:253], v19 offset:57344
v_exp_f32 v3, v182
v_mfma_f32_16x16x32_bf16 v[172:175], v[220:223], v[156:159], v[172:175]
ds_read_b64_tr_b16 v[254:255], v19 offset:61440
v_cvt_pk_bf16_f32 v60, v30, v31
v_mfma_f32_16x16x32_bf16 v[40:43], v[20:23], v[56:59], 0
s_waitcnt lgkmcnt(4)
v_mfma_f32_16x16x32_bf16 v[64:67], v[48:51], v[224:227], v[64:67]
ds_read_b128 v[192:195], v8 offset:57344
v_exp_f32 v4, v183
v_mfma_f32_16x16x32_bf16 v[80:83], v[52:55], v[224:227], v[80:83]
v_mfma_f32_16x16x32_bf16 v[68:71], v[48:51], v[228:231], v[68:71]
ds_read_b128 v[196:199], v9 offset:57344
v_exp_f32 v28, v188
v_mfma_f32_16x16x32_bf16 v[84:87], v[52:55], v[228:231], v[84:87]
v_exp_f32 v29, v189
v_cvt_pk_bf16_f32 v61, v3, v4
v_mfma_f32_16x16x32_bf16 v[72:75], v[48:51], v[232:235], v[72:75]
ds_read_b128 v[200:203], v10 offset:57344
v_exp_f32 v30, v190
v_mfma_f32_16x16x32_bf16 v[88:91], v[52:55], v[232:235], v[88:91]
v_cvt_pk_bf16_f32 v62, v28, v29
v_mfma_f32_16x16x32_bf16 v[76:79], v[48:51], v[236:239], v[76:79]
ds_read_b128 v[204:207], v11 offset:57344
v_exp_f32 v31, v191
v_mfma_f32_16x16x32_bf16 v[92:95], v[52:55], v[236:239], v[92:95]
v_mfma_f32_16x16x32_bf16 v[96:99], v[48:51], v[240:243], v[96:99]
ds_read_b128 v[208:211], v8 offset:61440
v_cvt_pk_bf16_f32 v63, v30, v31
v_mfma_f32_16x16x32_bf16 v[112:115], v[52:55], v[240:243], v[112:115]
v_mfma_f32_16x16x32_bf16 v[100:103], v[48:51], v[244:247], v[100:103]
ds_read_b128 v[212:215], v9 offset:61440
v_mfma_f32_16x16x32_bf16 v[44:47], v[20:23], v[60:63], 0
v_mfma_f32_16x16x32_bf16 v[116:119], v[52:55], v[244:247], v[116:119]
s_waitcnt lgkmcnt(6)
v_mfma_f32_16x16x32_bf16 v[104:107], v[48:51], v[248:251], v[104:107]
ds_read_b128 v[216:219], v10 offset:61440
v_mfma_f32_16x16x32_bf16 v[120:123], v[52:55], v[248:251], v[120:123]
v_mfma_f32_16x16x32_bf16 v[108:111], v[48:51], v[252:255], v[108:111]
ds_read_b128 v[220:223], v11 offset:61440
v_mfma_f32_16x16x32_bf16 v[124:127], v[52:55], v[252:255], v[124:127]
s_nop 0
v_max_f32 v27, v40, v44
v_cmp_lt_f32 vcc, s49, v27
s_cbranch_vccnz L_rare7
L_ret7:
v_add_f32 v25, v25, v40
v_add_f32 v26, v26, v44
s_branch L_loop
L_last:
s_lshr_b32 s54, s2, 5
s_lshl2_add_u32 s54, s54, s40
s_lshl_b32 s54, s54, 9
s_lshl_b32 s55, s42, 7
s_add_u32 s55, s55, s54
v_lshlrev_b32 v4, 16, v1
buffer_load_dword v33, v4, s[24:27], s55 offen offset:0 sc1
s_barrier
ds_read_b64_tr_b16 v[224:225], v12 offset:57344
ds_read_b64_tr_b16 v[226:227], v12 offset:61440
ds_read_b64_tr_b16 v[228:229], v13 offset:57344
ds_read_b64_tr_b16 v[230:231], v13 offset:61440
ds_read_b64_tr_b16 v[232:233], v14 offset:57344
ds_read_b64_tr_b16 v[234:235], v14 offset:61440
ds_read_b64_tr_b16 v[236:237], v15 offset:57344
ds_read_b64_tr_b16 v[238:239], v15 offset:61440
ds_read_b64_tr_b16 v[240:241], v16 offset:57344
ds_read_b64_tr_b16 v[242:243], v16 offset:61440
ds_read_b64_tr_b16 v[244:245], v17 offset:57344
ds_read_b64_tr_b16 v[246:247], v17 offset:61440
v_exp_f32 v160, v176
v_exp_f32 v161, v177
v_exp_f32 v162, v178
v_exp_f32 v163, v179
v_exp_f32 v164, v184
v_exp_f32 v165, v185
v_exp_f32 v166, v186
v_exp_f32 v167, v187
ds_read_b64_tr_b16 v[248:249], v18 offset:57344
ds_read_b64_tr_b16 v[250:251], v18 offset:61440
ds_read_b64_tr_b16 v[252:253], v19 offset:57344
ds_read_b64_tr_b16 v[254:255], v19 offset:61440
s_waitcnt lgkmcnt(8)
v_mfma_f32_16x16x32_bf16 v[64:67], v[48:51], v[224:227], v[64:67]
v_cvt_pk_bf16_f32 v56, v160, v161
v_cvt_pk_bf16_f32 v57, v162, v163
v_mfma_f32_16x16x32_bf16 v[80:83], v[52:55], v[224:227], v[80:83]
v_exp_f32 v168, v180
v_exp_f32 v169, v181
v_mfma_f32_16x16x32_bf16 v[68:71], v[48:51], v[228:231], v[68:71]
v_cvt_pk_bf16_f32 v58, v164, v165
v_cvt_pk_bf16_f32 v59, v166, v167
v_mfma_f32_16x16x32_bf16 v[84:87], v[52:55], v[228:231], v[84:87]
v_exp_f32 v170, v182
v_exp_f32 v171, v183
v_mfma_f32_16x16x32_bf16 v[72:75], v[48:51], v[232:235], v[72:75]
v_exp_f32 v172, v188
v_exp_f32 v173, v189
v_mfma_f32_16x16x32_bf16 v[88:91], v[52:55], v[232:235], v[88:91]
v_exp_f32 v174, v190
v_mfma_f32_16x16x32_bf16 v[76:79], v[48:51], v[236:239], v[76:79]
v_exp_f32 v175, v191
v_cvt_pk_bf16_f32 v60, v168, v169
v_mfma_f32_16x16x32_bf16 v[92:95], v[52:55], v[236:239], v[92:95]
v_cvt_pk_bf16_f32 v61, v170, v171
v_cvt_pk_bf16_f32 v62, v172, v173
s_waitcnt lgkmcnt(0)
s_barrier
v_mfma_f32_16x16x32_bf16 v[96:99], v[48:51], v[240:243], v[96:99]
ds_read_b64_tr_b16 v[208:209], v16 offset:0
ds_read_b64_tr_b16 v[210:211], v16 offset:4096
v_cvt_pk_bf16_f32 v63, v174, v175
v_mfma_f32_16x16x32_bf16 v[112:115], v[52:55], v[240:243], v[112:115]
ds_read_b64_tr_b16 v[212:213], v17 offset:0
ds_read_b64_tr_b16 v[214:215], v17 offset:4096
v_mfma_f32_16x16x32_bf16 v[40:43], v[20:23], v[56:59], 0
v_mfma_f32_16x16x32_bf16 v[100:103], v[48:51], v[244:247], v[100:103]
ds_read_b64_tr_b16 v[216:217], v18 offset:0
ds_read_b64_tr_b16 v[218:219], v18 offset:4096
v_lshlrev_b32 v7, 4, v1
v_mfma_f32_16x16x32_bf16 v[116:119], v[52:55], v[244:247], v[116:119]
ds_read_b64_tr_b16 v[220:221], v19 offset:0
ds_read_b64_tr_b16 v[222:223], v19 offset:4096
v_mfma_f32_16x16x32_bf16 v[44:47], v[20:23], v[60:63], 0
v_mfma_f32_16x16x32_bf16 v[104:107], v[48:51], v[248:251], v[104:107]
ds_read_b64_tr_b16 v[192:193], v12 offset:0
ds_read_b64_tr_b16 v[194:195], v12 offset:4096
s_mul_i32 s56, s42, 1024
v_mfma_f32_16x16x32_bf16 v[120:123], v[52:55], v[248:251], v[120:123]
ds_read_b64_tr_b16 v[196:197], v13 offset:0
ds_read_b64_tr_b16 v[198:199], v13 offset:4096
s_add_u32 s57, s56, 0x1000
v_mfma_f32_16x16x32_bf16 v[108:111], v[48:51], v[252:255], v[108:111]
ds_read_b64_tr_b16 v[200:201], v14 offset:0
ds_read_b64_tr_b16 v[202:203], v14 offset:4096
v_mfma_f32_16x16x32_bf16 v[124:127], v[52:55], v[252:255], v[124:127]
ds_read_b64_tr_b16 v[204:205], v15 offset:0
ds_read_b64_tr_b16 v[206:207], v15 offset:4096
v_max_f32 v27, v40, v44
v_cmp_lt_f32 vcc, s49, v27
s_cbranch_vccnz L_rareL
L_retL:
s_waitcnt lgkmcnt(12)
v_mfma_f32_16x16x32_bf16 v[96:99], v[56:59], v[208:211], v[96:99]
v_mfma_f32_16x16x32_bf16 v[112:115], v[60:63], v[208:211], v[112:115]
v_add_f32 v25, v25, v40
v_add_f32 v26, v26, v44
v_mfma_f32_16x16x32_bf16 v[100:103], v[56:59], v[212:215], v[100:103]
v_mfma_f32_16x16x32_bf16 v[116:119], v[60:63], v[212:215], v[116:119]
v_max_f32 v25, 0.5, v25
v_max_f32 v26, 0.5, v26
v_rcp_f32 v2, v25
v_rcp_f32 v6, v26
s_waitcnt lgkmcnt(8)
v_mfma_f32_16x16x32_bf16 v[104:107], v[56:59], v[216:219], v[104:107]
v_mfma_f32_16x16x32_bf16 v[120:123], v[60:63], v[216:219], v[120:123]
v_mfma_f32_16x16x32_bf16 v[108:111], v[56:59], v[220:223], v[108:111]
v_mfma_f32_16x16x32_bf16 v[124:127], v[60:63], v[220:223], v[124:127]
s_waitcnt lgkmcnt(0)
v_mfma_f32_16x16x32_bf16 v[80:83], v[60:63], v[192:195], v[80:83]
ds_bpermute_b32 v160, v24, v2 offset:0
ds_bpermute_b32 v161, v24, v2 offset:4
v_mfma_f32_16x16x32_bf16 v[84:87], v[60:63], v[196:199], v[84:87]
ds_bpermute_b32 v162, v24, v2 offset:8
ds_bpermute_b32 v163, v24, v2 offset:12
v_mfma_f32_16x16x32_bf16 v[88:91], v[60:63], v[200:203], v[88:91]
ds_bpermute_b32 v164, v24, v6 offset:0
ds_bpermute_b32 v165, v24, v6 offset:4
v_mfma_f32_16x16x32_bf16 v[92:95], v[60:63], v[204:207], v[92:95]
ds_bpermute_b32 v166, v24, v6 offset:8
ds_bpermute_b32 v167, v24, v6 offset:12
v_max_f32 v168, |v96|, |v100|
v_max_f32 v169, |v97|, |v101|
v_max_f32 v170, |v98|, |v102|
v_max_f32 v171, |v99|, |v103|
v_max_f32 v172, |v112|, |v116|
v_max_f32 v173, |v113|, |v117|
v_max_f32 v174, |v114|, |v118|
v_max_f32 v175, |v115|, |v119|
v_max3_f32 v168, |v104|, |v108|, v168
v_max3_f32 v169, |v105|, |v109|, v169
v_max3_f32 v170, |v106|, |v110|, v170
v_max3_f32 v171, |v107|, |v111|, v171
v_max3_f32 v172, |v120|, |v124|, v172
v_max3_f32 v173, |v121|, |v125|, v173
v_max3_f32 v174, |v122|, |v126|, v174
v_max3_f32 v175, |v123|, |v127|, v175
v_max3_f32 v172, |v80|, |v84|, v172
v_max3_f32 v173, |v81|, |v85|, v173
v_max3_f32 v174, |v82|, |v86|, v174
v_max3_f32 v175, |v83|, |v87|, v175
v_max3_f32 v172, |v88|, |v92|, v172
v_max3_f32 v173, |v89|, |v93|, v173
v_max3_f32 v174, |v90|, |v94|, v174
v_max3_f32 v175, |v91|, |v95|, v175
s_waitcnt lgkmcnt(0)
v_mul_f32 v168, v168, v160
v_mul_f32 v169, v169, v161
v_mul_f32 v170, v170, v162
v_mul_f32 v171, v171, v163
v_mul_f32 v172, v172, v164
v_mul_f32 v173, v173, v165
v_mul_f32 v174, v174, v166
v_mul_f32 v175, v175, v167
v_max3_f32 v27, v168, v169, v170
v_max3_f32 v5, v171, v172, v173
v_max3_f32 v27, v27, v174, v175
v_max_f32 v27, v27, v5
v_mfma_f32_16x16x32_bf16 v[64:67], v[56:59], v[192:195], v[64:67]
s_nop 0
v_max_f32_dpp v27, v27, v27 row_ror:1 row_mask:0xf bank_mask:0xf
v_mfma_f32_16x16x32_bf16 v[68:71], v[56:59], v[196:199], v[68:71]
s_nop 0
v_max_f32_dpp v27, v27, v27 row_ror:2 row_mask:0xf bank_mask:0xf
v_mfma_f32_16x16x32_bf16 v[72:75], v[56:59], v[200:203], v[72:75]
s_nop 0
v_max_f32_dpp v27, v27, v27 row_ror:4 row_mask:0xf bank_mask:0xf
v_mfma_f32_16x16x32_bf16 v[76:79], v[56:59], v[204:207], v[76:79]
s_nop 0
v_max_f32_dpp v27, v27, v27 row_ror:8 row_mask:0xf bank_mask:0xf
v_frexp_exp_i32_f32 v27, v27
v_sub_u32 v27, 15, v27
v_min_i32 v27, 0x78, v27
v_ldexp_f32 v160, v160, v27
v_ldexp_f32 v161, v161, v27
v_ldexp_f32 v162, v162, v27
v_ldexp_f32 v163, v163, v27
v_ldexp_f32 v164, v164, v27
v_ldexp_f32 v165, v165, v27
v_ldexp_f32 v166, v166, v27
v_ldexp_f32 v167, v167, v27
v_fma_mixlo_f16 v224, v80, v164, 0
v_fma_mixlo_f16 v225, v82, v166, 0
v_fma_mixlo_f16 v226, v84, v164, 0
v_fma_mixlo_f16 v227, v86, v166, 0
v_fma_mixlo_f16 v228, v88, v164, 0
v_fma_mixlo_f16 v229, v90, v166, 0
v_fma_mixlo_f16 v230, v92, v164, 0
v_fma_mixlo_f16 v231, v94, v166, 0
v_fma_mixhi_f16 v224, v81, v165, 0
v_fma_mixhi_f16 v225, v83, v167, 0
v_fma_mixhi_f16 v226, v85, v165, 0
v_fma_mixhi_f16 v227, v87, v167, 0
v_fma_mixhi_f16 v228, v89, v165, 0
v_fma_mixhi_f16 v229, v91, v167, 0
v_fma_mixhi_f16 v230, v93, v165, 0
v_fma_mixhi_f16 v231, v95, v167, 0
buffer_store_dwordx4 v[224:227], v7, s[32:35], s56 offen sc1
s_add_u32 s56, s56, 0x1000
buffer_store_dwordx4 v[228:231], v7, s[32:35], s56 offen sc1
s_add_u32 s56, s56, 0x1000
v_fma_mixlo_f16 v232, v96, v160, 0
v_fma_mixlo_f16 v233, v98, v162, 0
v_fma_mixlo_f16 v234, v100, v160, 0
v_fma_mixlo_f16 v235, v102, v162, 0
v_fma_mixlo_f16 v236, v104, v160, 0
v_fma_mixlo_f16 v237, v106, v162, 0
v_fma_mixlo_f16 v238, v108, v160, 0
v_fma_mixlo_f16 v239, v110, v162, 0
v_fma_mixhi_f16 v232, v97, v161, 0
v_fma_mixhi_f16 v233, v99, v163, 0
v_fma_mixhi_f16 v234, v101, v161, 0
v_fma_mixhi_f16 v235, v103, v163, 0
v_fma_mixhi_f16 v236, v105, v161, 0
v_fma_mixhi_f16 v237, v107, v163, 0
v_fma_mixhi_f16 v238, v109, v161, 0
v_fma_mixhi_f16 v239, v111, v163, 0
buffer_store_dwordx4 v[232:235], v7, s[32:35], s56 offen sc1
s_add_u32 s56, s56, 0x1000
buffer_store_dwordx4 v[236:239], v7, s[32:35], s56 offen sc1
s_add_u32 s56, s56, 0x1000
v_fma_mixlo_f16 v240, v112, v164, 0
v_fma_mixlo_f16 v241, v114, v166, 0
v_fma_mixlo_f16 v242, v116, v164, 0
v_fma_mixlo_f16 v243, v118, v166, 0
v_fma_mixlo_f16 v244, v120, v164, 0
v_fma_mixlo_f16 v245, v122, v166, 0
v_fma_mixlo_f16 v246, v124, v164, 0
v_fma_mixlo_f16 v247, v126, v166, 0
v_fma_mixhi_f16 v240, v113, v165, 0
v_fma_mixhi_f16 v241, v115, v167, 0
v_fma_mixhi_f16 v242, v117, v165, 0
v_fma_mixhi_f16 v243, v119, v167, 0
v_fma_mixhi_f16 v244, v121, v165, 0
v_fma_mixhi_f16 v245, v123, v167, 0
v_fma_mixhi_f16 v246, v125, v165, 0
v_fma_mixhi_f16 v247, v127, v167, 0
buffer_store_dwordx4 v[240:243], v7, s[32:35], s56 offen sc1
s_add_u32 s56, s56, 0x1000
buffer_store_dwordx4 v[244:247], v7, s[32:35], s56 offen sc1
s_add_u32 s56, s56, 0x1000
v_and_b32 v3, 0xc0, v7
v_add_u32 v27, 0x80, v27
v_log_f32 v25, v25
v_log_f32 v26, v26
ds_bpermute_b32 v4, v3, v27
v_cmp_gt_u32 vcc, 16, v1
v_sub_f32 v25, v25, v32
v_sub_f32 v26, v26, v36
v_and_b32 v2, 3, v1
v_cndmask_b32 v8, v26, v25, vcc
v_lshlrev_b32 v3, 1, v2
s_and_b32 s53, s42, 1
s_lshl_b32 s52, s53, 6
v_lshlrev_b32 v9, 2, v1
v_xor_b32 v9, s52, v9
v_lshlrev_b32 v11, 4, v2
v_bfe_u32 v10, v1, 2, 2
v_xor_b32 v10, s42, v10
v_lshl_add_u32 v10, v10, 7, v11
s_add_u32 s54, s54, s52
s_xor_b32 s57, s42, 1
s_mul_i32 s57, s57, 1024
s_add_u32 s60, s57, 4096
s_xor_b32 s58, s42, 2
s_mul_i32 s58, s58, 1024
s_add_u32 s58, s58, 8192
s_add_u32 s61, s58, 4096
s_xor_b32 s59, s42, 3
s_mul_i32 s59, s59, 1024
s_add_u32 s59, s59, 16384
s_add_u32 s62, s59, 4096
s_waitcnt lgkmcnt(0)
v_bfe_u32 v4, v4, v3, 2
v_lshl_or_b32 v4, v4, 1, 1
v_bfi_b32 v8, 7, v4, v8
ds_bpermute_b32 v12, v11, v8 offset:0
ds_bpermute_b32 v13, v11, v8 offset:4
ds_bpermute_b32 v14, v11, v8 offset:8
ds_bpermute_b32 v15, v11, v8 offset:12
s_mov_b32 s63, 0x1fffff
s_waitcnt lgkmcnt(0)
s_mov_b64 exec, 0xfff0
s_waitcnt vmcnt(0)
s_mov_b32 exec_lo, -1
buffer_store_dword v8, v9, s[24:27], s55 offen offset:0
s_mov_b32 exec_lo, 0xfff0
buffer_load_dwordx4 v[12:15], v10, s[24:27], s54 offen offset:0 sc1
s_waitcnt vmcnt(0)
L_poll:
v_and_b32 v3, v12, v13
v_and_b32 v4, v14, v15
v_and_b32 v3, v3, v4
v_and_b32 v3, 1, v3
v_cmp_ne_u32 vcc, 1, v3
s_cbranch_vccz L_go
s_mov_b64 exec, vcc
s_and_b32 s44, s63, 15
s_cbranch_scc0 L_pollb
buffer_load_dwordx4 v[12:15], v10, s[24:27], s54 offen offset:0 sc1
L_pollw:
s_sub_u32 s63, s63, 1
s_waitcnt vmcnt(0)
s_cbranch_scc0 L_poll
L_go:
s_mov_b64 exec, -1
buffer_load_dwordx4 v[224:227], v7, s[32:35], s57 offen offset:0 sc1
buffer_load_dwordx4 v[228:231], v7, s[32:35], s60 offen offset:0 sc1
buffer_load_dwordx4 v[232:235], v7, s[32:35], s58 offen offset:0 sc1
buffer_load_dwordx4 v[236:239], v7, s[32:35], s61 offen offset:0 sc1
buffer_load_dwordx4 v[240:243], v7, s[32:35], s59 offen offset:0 sc1
buffer_load_dwordx4 v[244:247], v7, s[32:35], s62 offen offset:0 sc1
v_mov_b32 v34, v9
v_max_f32_dpp v16, v12, v12 row_ror:4 row_mask:0xf bank_mask:0xf
v_max_f32_dpp v17, v13, v13 row_ror:4 row_mask:0xf bank_mask:0xf
v_max_f32_dpp v18, v14, v14 row_ror:4 row_mask:0xf bank_mask:0xf
v_max_f32_dpp v19, v15, v15 row_ror:4 row_mask:0xf bank_mask:0xf
v_max_f32_dpp v16, v16, v16 row_ror:8 row_mask:0xf bank_mask:0xf
v_max_f32_dpp v17, v17, v17 row_ror:8 row_mask:0xf bank_mask:0xf
v_max_f32_dpp v18, v18, v18 row_ror:8 row_mask:0xf bank_mask:0xf
v_max_f32_dpp v19, v19, v19 row_ror:8 row_mask:0xf bank_mask:0xf
v_bfe_u32 v28, v12, 1, 2
v_bfe_u32 v29, v13, 1, 2
v_bfe_u32 v30, v14, 1, 2
v_bfe_u32 v31, v15, 1, 2
v_sub_f32 v12, v12, v16
v_sub_f32 v13, v13, v17
v_sub_f32 v14, v14, v18
v_sub_f32 v15, v15, v19
v_exp_f32 v12, v12
v_exp_f32 v13, v13
v_exp_f32 v14, v14
v_exp_f32 v15, v15
v_lshl_or_b32 v28, v29, 2, v28
v_lshl_or_b32 v28, v30, 4, v28
v_lshl_or_b32 v28, v31, 6, v28
v_add_f32_dpp v16, v12, v12 row_ror:4 row_mask:0xf bank_mask:0xf
v_add_f32_dpp v17, v13, v13 row_ror:4 row_mask:0xf bank_mask:0xf
v_add_f32_dpp v18, v14, v14 row_ror:4 row_mask:0xf bank_mask:0xf
v_add_f32_dpp v19, v15, v15 row_ror:4 row_mask:0xf bank_mask:0xf
v_add_f32_dpp v16, v16, v16 row_ror:8 row_mask:0xf bank_mask:0xf
v_add_f32_dpp v17, v17, v17 row_ror:8 row_mask:0xf bank_mask:0xf
v_add_f32_dpp v18, v18, v18 row_ror:8 row_mask:0xf bank_mask:0xf
v_add_f32_dpp v19, v19, v19 row_ror:8 row_mask:0xf bank_mask:0xf
v_rcp_f32 v16, v16
v_rcp_f32 v17, v17
v_rcp_f32 v18, v18
v_rcp_f32 v19, v19
v_sub_u32 v28, 0x80, v28
v_lshrrev_b32 v3, 2, v24
v_mul_f32 v12, v12, v16
v_mul_f32 v13, v13, v17
v_mul_f32 v14, v14, v18
v_mul_f32 v15, v15, v19
v_ldexp_f32 v12, v12, v28
v_ldexp_f32 v13, v13, v28
v_ldexp_f32 v14, v14, v28
v_ldexp_f32 v15, v15, v28
ds_bpermute_b32 v176, v3, v12 offset:0
ds_bpermute_b32 v177, v3, v13 offset:0
ds_bpermute_b32 v178, v3, v14 offset:0
ds_bpermute_b32 v179, v3, v15 offset:0
ds_bpermute_b32 v180, v3, v12 offset:16
ds_bpermute_b32 v181, v3, v13 offset:16
ds_bpermute_b32 v182, v3, v14 offset:16
ds_bpermute_b32 v183, v3, v15 offset:16
ds_bpermute_b32 v184, v3, v12 offset:32
ds_bpermute_b32 v185, v3, v13 offset:32
ds_bpermute_b32 v186, v3, v14 offset:32
ds_bpermute_b32 v187, v3, v15 offset:32
ds_bpermute_b32 v188, v3, v12 offset:48
ds_bpermute_b32 v189, v3, v13 offset:48
ds_bpermute_b32 v190, v3, v14 offset:48
ds_bpermute_b32 v191, v3, v15 offset:48
s_waitcnt lgkmcnt(12)
v_mul_f32 v160, v176, v160
v_mul_f32 v161, v177, v161
v_mul_f32 v162, v178, v162
v_mul_f32 v163, v179, v163
v_mul_f32 v64, v160, v64
v_mul_f32 v65, v161, v65
v_mul_f32 v66, v162, v66
v_mul_f32 v67, v163, v67
v_mul_f32 v68, v160, v68
v_mul_f32 v69, v161, v69
v_mul_f32 v70, v162, v70
v_mul_f32 v71, v163, v71
v_mul_f32 v72, v160, v72
v_mul_f32 v73, v161, v73
v_mul_f32 v74, v162, v74
v_mul_f32 v75, v163, v75
v_mul_f32 v76, v160, v76
v_mul_f32 v77, v161, v77
v_mul_f32 v78, v162, v78
v_mul_f32 v79, v163, v79
s_lshl_b32 s52, s40, 13
s_add_u32 s52, s52, 0x20000
v_mul_u32_u24 v3, 144, v3
v_and_b32 v4, 15, v1
v_lshl_add_u32 v3, v4, 1, v3
v_add_u32 v10, s52, v3
v_lshrrev_b32 v3, 3, v1
v_and_b32 v4, 0x70, v7
v_lshl_add_u32 v9, v3, 8, v4
v_mul_u32_u24 v3, 144, v3
v_add3_u32 v11, v3, v4, s52
s_lshl_b32 s53, s53, 12
s_and_b32 s52, s42, 2
s_lshl_b32 s52, s52, 6
s_add_u32 s53, s53, s52
s_mov_b32 exec_hi, 0
buffer_store_dword v8, v34, s[24:27], s55 offen sc1
s_mov_b32 exec_hi, -1
s_waitcnt vmcnt(5) lgkmcnt(0)
v_fma_mix_f32 v64, v224, v180, v64 op_sel_hi:[1,0,0]
v_fma_mix_f32 v65, v224, v181, v65 op_sel:[1,0,0] op_sel_hi:[1,0,0]
v_fma_mix_f32 v66, v225, v182, v66 op_sel_hi:[1,0,0]
v_fma_mix_f32 v67, v225, v183, v67 op_sel:[1,0,0] op_sel_hi:[1,0,0]
v_fma_mix_f32 v68, v226, v180, v68 op_sel_hi:[1,0,0]
v_fma_mix_f32 v69, v226, v181, v69 op_sel:[1,0,0] op_sel_hi:[1,0,0]
v_fma_mix_f32 v70, v227, v182, v70 op_sel_hi:[1,0,0]
v_fma_mix_f32 v71, v227, v183, v71 op_sel:[1,0,0] op_sel_hi:[1,0,0]
v_fma_mix_f32 v72, v228, v180, v72 op_sel_hi:[1,0,0]
v_fma_mix_f32 v73, v228, v181, v73 op_sel:[1,0,0] op_sel_hi:[1,0,0]
v_fma_mix_f32 v74, v229, v182, v74 op_sel_hi:[1,0,0]
v_fma_mix_f32 v75, v229, v183, v75 op_sel:[1,0,0] op_sel_hi:[1,0,0]
v_fma_mix_f32 v76, v230, v180, v76 op_sel_hi:[1,0,0]
v_fma_mix_f32 v77, v230, v181, v77 op_sel:[1,0,0] op_sel_hi:[1,0,0]
v_fma_mix_f32 v78, v231, v182, v78 op_sel_hi:[1,0,0]
v_fma_mix_f32 v79, v231, v183, v79 op_sel:[1,0,0] op_sel_hi:[1,0,0]
s_waitcnt vmcnt(3)
v_fma_mix_f32 v64, v232, v184, v64 op_sel_hi:[1,0,0]
v_fma_mix_f32 v65, v232, v185, v65 op_sel:[1,0,0] op_sel_hi:[1,0,0]
v_fma_mix_f32 v66, v233, v186, v66 op_sel_hi:[1,0,0]
v_fma_mix_f32 v67, v233, v187, v67 op_sel:[1,0,0] op_sel_hi:[1,0,0]
v_fma_mix_f32 v68, v234, v184, v68 op_sel_hi:[1,0,0]
v_fma_mix_f32 v69, v234, v185, v69 op_sel:[1,0,0] op_sel_hi:[1,0,0]
v_fma_mix_f32 v70, v235, v186, v70 op_sel_hi:[1,0,0]
v_fma_mix_f32 v71, v235, v187, v71 op_sel:[1,0,0] op_sel_hi:[1,0,0]
v_fma_mix_f32 v72, v236, v184, v72 op_sel_hi:[1,0,0]
v_fma_mix_f32 v73, v236, v185, v73 op_sel:[1,0,0] op_sel_hi:[1,0,0]
v_fma_mix_f32 v74, v237, v186, v74 op_sel_hi:[1,0,0]
v_fma_mix_f32 v75, v237, v187, v75 op_sel:[1,0,0] op_sel_hi:[1,0,0]
v_fma_mix_f32 v76, v238, v184, v76 op_sel_hi:[1,0,0]
v_fma_mix_f32 v77, v238, v185, v77 op_sel:[1,0,0] op_sel_hi:[1,0,0]
v_fma_mix_f32 v78, v239, v186, v78 op_sel_hi:[1,0,0]
v_fma_mix_f32 v79, v239, v187, v79 op_sel:[1,0,0] op_sel_hi:[1,0,0]
s_waitcnt vmcnt(1)
v_fma_mix_f32 v64, v240, v188, v64 op_sel_hi:[1,0,0]
v_fma_mix_f32 v65, v240, v189, v65 op_sel:[1,0,0] op_sel_hi:[1,0,0]
v_fma_mix_f32 v66, v241, v190, v66 op_sel_hi:[1,0,0]
v_fma_mix_f32 v67, v241, v191, v67 op_sel:[1,0,0] op_sel_hi:[1,0,0]
v_fma_mix_f32 v68, v242, v188, v68 op_sel_hi:[1,0,0]
v_fma_mix_f32 v69, v242, v189, v69 op_sel:[1,0,0] op_sel_hi:[1,0,0]
v_fma_mix_f32 v70, v243, v190, v70 op_sel_hi:[1,0,0]
v_fma_mix_f32 v71, v243, v191, v71 op_sel:[1,0,0] op_sel_hi:[1,0,0]
v_fma_mix_f32 v72, v244, v188, v72 op_sel_hi:[1,0,0]
v_fma_mix_f32 v73, v244, v189, v73 op_sel:[1,0,0] op_sel_hi:[1,0,0]
v_fma_mix_f32 v74, v245, v190, v74 op_sel_hi:[1,0,0]
v_fma_mix_f32 v75, v245, v191, v75 op_sel:[1,0,0] op_sel_hi:[1,0,0]
v_fma_mix_f32 v76, v246, v188, v76 op_sel_hi:[1,0,0]
v_fma_mix_f32 v77, v246, v189, v77 op_sel:[1,0,0] op_sel_hi:[1,0,0]
v_fma_mix_f32 v78, v247, v190, v78 op_sel_hi:[1,0,0]
v_fma_mix_f32 v79, v247, v191, v79 op_sel:[1,0,0] op_sel_hi:[1,0,0]
v_cvt_pk_bf16_f32 v80, v64, v65
v_cvt_pk_bf16_f32 v81, v66, v67
v_cvt_pk_bf16_f32 v82, v68, v69
v_cvt_pk_bf16_f32 v83, v70, v71
v_cvt_pk_bf16_f32 v84, v72, v73
v_cvt_pk_bf16_f32 v85, v74, v75
v_cvt_pk_bf16_f32 v86, v76, v77
v_cvt_pk_bf16_f32 v87, v78, v79
ds_write_b16 v10, v80 offset:0
ds_write_b16_d16_hi v10, v80 offset:144
ds_write_b16 v10, v81 offset:288
ds_write_b16_d16_hi v10, v81 offset:432
ds_write_b16 v10, v82 offset:32
ds_write_b16_d16_hi v10, v82 offset:176
ds_write_b16 v10, v83 offset:320
ds_write_b16_d16_hi v10, v83 offset:464
ds_write_b16 v10, v84 offset:64
ds_write_b16_d16_hi v10, v84 offset:208
ds_write_b16 v10, v85 offset:352
ds_write_b16_d16_hi v10, v85 offset:496
ds_write_b16 v10, v86 offset:96
ds_write_b16_d16_hi v10, v86 offset:240
ds_write_b16 v10, v87 offset:384
ds_write_b16_d16_hi v10, v87 offset:528
ds_read_b128 v[64:67], v11 offset:0
ds_read_b128 v[68:71], v11 offset:1152
s_waitcnt lgkmcnt(1)
buffer_store_dwordx4 v[64:67], v9, s[28:31], s53 offen offset:0 sc1
s_waitcnt lgkmcnt(0)
buffer_store_dwordx4 v[68:71], v9, s[28:31], s53 offen offset:2048 sc1
L_end:
s_endpgm
L_pollb:
s_mov_b32 exec_lo, -1
buffer_store_dword v8, v9, s[24:27], s55 offen sc1
s_mov_b32 exec_lo, vcc_lo
buffer_load_dwordx4 v[12:15], v10, s[24:27], s54 offen sc1
s_branch L_pollw
L_rare0:
s_mov_b32 s43, 49152
s_mov_b32 s46, 57344
s_call_b64 s[50:51], L_rescale0
s_branch L_ret0
L_rare1:
s_mov_b32 s43, 57344
s_mov_b32 s46, 0
s_call_b64 s[50:51], L_rescale1
s_branch L_ret1
L_rare2:
s_mov_b32 s43, 0
s_mov_b32 s46, 8192
s_call_b64 s[50:51], L_rescale0
s_branch L_ret2
L_rare3:
s_mov_b32 s43, 8192
s_mov_b32 s46, 16384
s_call_b64 s[50:51], L_rescale1
s_branch L_ret3
L_rare4:
s_mov_b32 s43, 16384
s_mov_b32 s46, 24576
s_call_b64 s[50:51], L_rescale0
s_branch L_ret4
L_rare5:
s_mov_b32 s43, 24576
s_mov_b32 s46, 32768
s_call_b64 s[50:51], L_rescale1
s_branch L_ret5
L_rare6:
s_mov_b32 s43, 32768
s_mov_b32 s46, 40960
s_call_b64 s[50:51], L_rescale0
s_branch L_ret6
L_rare7:
s_mov_b32 s43, 40960
s_mov_b32 s46, 49152
s_call_b64 s[50:51], L_rescale1
s_branch L_ret7
L_rareL:
s_mov_b32 s43, 40960
s_mov_b32 s46, 49152
s_call_b64 s[50:51], L_rescale1
s_branch L_retL
L_rescale0:
v_add_u32 v28, s46, v8
v_add_u32 v29, s46, v9
v_add_u32 v30, s46, v10
v_add_u32 v31, s46, v11
s_nop 7
ds_read_b128 v[224:227], v28 offset:0
ds_read_b128 v[228:231], v29 offset:0
ds_read_b128 v[232:235], v30 offset:0
ds_read_b128 v[236:239], v31 offset:0
ds_read_b128 v[240:243], v28 offset:4096
ds_read_b128 v[244:247], v29 offset:4096
ds_read_b128 v[248:251], v30 offset:4096
ds_read_b128 v[252:255], v31 offset:4096
s_waitcnt lgkmcnt(0)
v_mfma_f32_16x16x32_bf16 v[176:179], v[224:227], v[128:131], 0
v_mfma_f32_16x16x32_bf16 v[180:183], v[224:227], v[144:147], 0
v_mfma_f32_16x16x32_bf16 v[176:179], v[228:231], v[132:135], v[176:179]
v_mfma_f32_16x16x32_bf16 v[180:183], v[228:231], v[148:151], v[180:183]
v_mfma_f32_16x16x32_bf16 v[176:179], v[232:235], v[136:139], v[176:179]
v_mfma_f32_16x16x32_bf16 v[180:183], v[232:235], v[152:155], v[180:183]
v_mfma_f32_16x16x32_bf16 v[176:179], v[236:239], v[140:143], v[176:179]
v_mfma_f32_16x16x32_bf16 v[180:183], v[236:239], v[156:159], v[180:183]
v_mfma_f32_16x16x32_bf16 v[184:187], v[240:243], v[128:131], 0
v_mfma_f32_16x16x32_bf16 v[188:191], v[240:243], v[144:147], 0
v_mfma_f32_16x16x32_bf16 v[184:187], v[244:247], v[132:135], v[184:187]
v_mfma_f32_16x16x32_bf16 v[188:191], v[244:247], v[148:151], v[188:191]
v_mfma_f32_16x16x32_bf16 v[184:187], v[248:251], v[136:139], v[184:187]
v_mfma_f32_16x16x32_bf16 v[188:191], v[248:251], v[152:155], v[188:191]
v_mfma_f32_16x16x32_bf16 v[184:187], v[252:255], v[140:143], v[184:187]
v_mfma_f32_16x16x32_bf16 v[188:191], v[252:255], v[156:159], v[188:191]
v_add_u32 v28, s43, v8
v_add_u32 v29, s43, v9
v_add_u32 v30, s43, v10
v_add_u32 v31, s43, v11
s_nop 7
ds_read_b128 v[224:227], v28 offset:0
ds_read_b128 v[228:231], v29 offset:0
ds_read_b128 v[232:235], v30 offset:0
ds_read_b128 v[236:239], v31 offset:0
ds_read_b128 v[240:243], v28 offset:4096
ds_read_b128 v[244:247], v29 offset:4096
ds_read_b128 v[248:251], v30 offset:4096
ds_read_b128 v[252:255], v31 offset:4096
s_waitcnt lgkmcnt(0)
v_mfma_f32_16x16x32_bf16 v[160:163], v[224:227], v[128:131], 0
v_mfma_f32_16x16x32_bf16 v[164:167], v[224:227], v[144:147], 0
v_mfma_f32_16x16x32_bf16 v[160:163], v[228:231], v[132:135], v[160:163]
v_mfma_f32_16x16x32_bf16 v[164:167], v[228:231], v[148:151], v[164:167]
v_mfma_f32_16x16x32_bf16 v[160:163], v[232:235], v[136:139], v[160:163]
v_mfma_f32_16x16x32_bf16 v[164:167], v[232:235], v[152:155], v[164:167]
v_mfma_f32_16x16x32_bf16 v[160:163], v[236:239], v[140:143], v[160:163]
v_mfma_f32_16x16x32_bf16 v[164:167], v[236:239], v[156:159], v[164:167]
v_mfma_f32_16x16x32_bf16 v[168:171], v[240:243], v[128:131], 0
v_mfma_f32_16x16x32_bf16 v[172:175], v[240:243], v[144:147], 0
v_mfma_f32_16x16x32_bf16 v[168:171], v[244:247], v[132:135], v[168:171]
v_mfma_f32_16x16x32_bf16 v[172:175], v[244:247], v[148:151], v[172:175]
v_mfma_f32_16x16x32_bf16 v[168:171], v[248:251], v[136:139], v[168:171]
v_mfma_f32_16x16x32_bf16 v[172:175], v[248:251], v[152:155], v[172:175]
v_mfma_f32_16x16x32_bf16 v[168:171], v[252:255], v[140:143], v[168:171]
v_mfma_f32_16x16x32_bf16 v[172:175], v[252:255], v[156:159], v[172:175]
s_nop 7
v_max3_f32 v27, v160, v161, v162
v_max3_f32 v27, v27, v163, v168
v_max3_f32 v27, v27, v169, v170
v_max3_f32 v27, v27, v171, -v32
v_max3_f32 v5, v164, v165, v166
v_max3_f32 v5, v5, v167, v172
v_max3_f32 v5, v5, v173, v174
v_max3_f32 v5, v5, v175, -v36
v_mov_b32 v2, v27
v_mov_b32 v6, v5
s_nop 1
v_permlane32_swap_b32 v27, v2
v_permlane32_swap_b32 v5, v6
v_max_f32 v27, v27, v2
v_max_f32 v5, v5, v6
v_mov_b32 v2, v27
v_mov_b32 v6, v5
s_nop 1
v_permlane16_swap_b32 v27, v2
v_permlane16_swap_b32 v5, v6
v_max_f32 v27, v27, v2
v_max_f32 v5, v5, v6
v_add_f32 v2, v32, v27
v_add_f32 v6, v36, v5
v_exp_f32 v2, -v2
v_exp_f32 v6, -v6
v_sub_f32 v32, 0, v27
v_sub_f32 v33, 0, v27
v_sub_f32 v34, 0, v27
v_sub_f32 v35, 0, v27
v_sub_f32 v36, 0, v5
v_sub_f32 v37, 0, v5
v_sub_f32 v38, 0, v5
v_sub_f32 v39, 0, v5
ds_bpermute_b32 v224, v24, v2 offset:0
ds_bpermute_b32 v225, v24, v2 offset:4
ds_bpermute_b32 v226, v24, v2 offset:8
ds_bpermute_b32 v227, v24, v2 offset:12
ds_bpermute_b32 v228, v24, v6 offset:0
ds_bpermute_b32 v229, v24, v6 offset:4
ds_bpermute_b32 v230, v24, v6 offset:8
ds_bpermute_b32 v231, v24, v6 offset:12
v_sub_f32 v176, v176, v27
v_sub_f32 v177, v177, v27
v_sub_f32 v178, v178, v27
v_sub_f32 v179, v179, v27
v_sub_f32 v180, v180, v5
v_sub_f32 v181, v181, v5
v_sub_f32 v182, v182, v5
v_sub_f32 v183, v183, v5
v_sub_f32 v184, v184, v27
v_sub_f32 v185, v185, v27
v_sub_f32 v186, v186, v27
v_sub_f32 v187, v187, v27
v_sub_f32 v188, v188, v5
v_sub_f32 v189, v189, v5
v_sub_f32 v190, v190, v5
v_sub_f32 v191, v191, v5
v_sub_f32 v160, v160, v27
v_sub_f32 v161, v161, v27
v_sub_f32 v162, v162, v27
v_sub_f32 v163, v163, v27
v_sub_f32 v164, v164, v5
v_sub_f32 v165, v165, v5
v_sub_f32 v166, v166, v5
v_sub_f32 v167, v167, v5
v_sub_f32 v168, v168, v27
v_sub_f32 v169, v169, v27
v_sub_f32 v170, v170, v27
v_sub_f32 v171, v171, v27
v_sub_f32 v172, v172, v5
v_sub_f32 v173, v173, v5
v_sub_f32 v174, v174, v5
v_sub_f32 v175, v175, v5
v_exp_f32 v160, v160
v_exp_f32 v161, v161
v_exp_f32 v162, v162
v_exp_f32 v163, v163
v_exp_f32 v164, v164
v_exp_f32 v165, v165
v_exp_f32 v166, v166
v_exp_f32 v167, v167
v_exp_f32 v168, v168
v_exp_f32 v169, v169
v_exp_f32 v170, v170
v_exp_f32 v171, v171
v_exp_f32 v172, v172
v_exp_f32 v173, v173
v_exp_f32 v174, v174
v_exp_f32 v175, v175
v_mul_f32 v25, v2, v25
v_mul_f32 v26, v6, v26
v_cvt_pk_bf16_f32 v48, v160, v161
v_cvt_pk_bf16_f32 v49, v162, v163
v_cvt_pk_bf16_f32 v52, v164, v165
v_cvt_pk_bf16_f32 v53, v166, v167
v_cvt_pk_bf16_f32 v50, v168, v169
v_cvt_pk_bf16_f32 v51, v170, v171
v_cvt_pk_bf16_f32 v54, v172, v173
v_cvt_pk_bf16_f32 v55, v174, v175
s_nop 0
s_waitcnt lgkmcnt(0)
v_mfma_f32_16x16x32_bf16 v[40:43], v[20:23], v[48:51], 0
v_mfma_f32_16x16x32_bf16 v[44:47], v[20:23], v[52:55], 0
v_mul_f32 v64, v224, v64
v_mul_f32 v65, v225, v65
v_mul_f32 v66, v226, v66
v_mul_f32 v67, v227, v67
v_mul_f32 v68, v224, v68
v_mul_f32 v69, v225, v69
v_mul_f32 v70, v226, v70
v_mul_f32 v71, v227, v71
v_mul_f32 v72, v224, v72
v_mul_f32 v73, v225, v73
v_mul_f32 v74, v226, v74
v_mul_f32 v75, v227, v75
v_mul_f32 v76, v224, v76
v_mul_f32 v77, v225, v77
v_mul_f32 v78, v226, v78
v_mul_f32 v79, v227, v79
v_mul_f32 v80, v228, v80
v_mul_f32 v81, v229, v81
v_mul_f32 v82, v230, v82
v_mul_f32 v83, v231, v83
v_mul_f32 v84, v228, v84
v_mul_f32 v85, v229, v85
v_mul_f32 v86, v230, v86
v_mul_f32 v87, v231, v87
v_mul_f32 v88, v228, v88
v_mul_f32 v89, v229, v89
v_mul_f32 v90, v230, v90
v_mul_f32 v91, v231, v91
v_mul_f32 v92, v228, v92
v_mul_f32 v93, v229, v93
v_mul_f32 v94, v230, v94
v_mul_f32 v95, v231, v95
v_mul_f32 v96, v224, v96
v_mul_f32 v97, v225, v97
v_mul_f32 v98, v226, v98
v_mul_f32 v99, v227, v99
v_mul_f32 v100, v224, v100
v_mul_f32 v101, v225, v101
v_mul_f32 v102, v226, v102
v_mul_f32 v103, v227, v103
v_mul_f32 v104, v224, v104
v_mul_f32 v105, v225, v105
v_mul_f32 v106, v226, v106
v_mul_f32 v107, v227, v107
v_mul_f32 v108, v224, v108
v_mul_f32 v109, v225, v109
v_mul_f32 v110, v226, v110
v_mul_f32 v111, v227, v111
v_mul_f32 v112, v228, v112
v_mul_f32 v113, v229, v113
v_mul_f32 v114, v230, v114
v_mul_f32 v115, v231, v115
v_mul_f32 v116, v228, v116
v_mul_f32 v117, v229, v117
v_mul_f32 v118, v230, v118
v_mul_f32 v119, v231, v119
v_mul_f32 v120, v228, v120
v_mul_f32 v121, v229, v121
v_mul_f32 v122, v230, v122
v_mul_f32 v123, v231, v123
v_mul_f32 v124, v228, v124
v_mul_f32 v125, v229, v125
v_mul_f32 v126, v230, v126
v_mul_f32 v127, v231, v127
s_setpc_b64 s[50:51]
L_rescale1:
v_add_u32 v28, s46, v8
v_add_u32 v29, s46, v9
v_add_u32 v30, s46, v10
v_add_u32 v31, s46, v11
s_nop 7
ds_read_b128 v[224:227], v28 offset:0
ds_read_b128 v[228:231], v29 offset:0
ds_read_b128 v[232:235], v30 offset:0
ds_read_b128 v[236:239], v31 offset:0
ds_read_b128 v[240:243], v28 offset:4096
ds_read_b128 v[244:247], v29 offset:4096
ds_read_b128 v[248:251], v30 offset:4096
ds_read_b128 v[252:255], v31 offset:4096
s_waitcnt lgkmcnt(0)
v_mfma_f32_16x16x32_bf16 v[160:163], v[224:227], v[128:131], 0
v_mfma_f32_16x16x32_bf16 v[164:167], v[224:227], v[144:147], 0
v_mfma_f32_16x16x32_bf16 v[160:163], v[228:231], v[132:135], v[160:163]
v_mfma_f32_16x16x32_bf16 v[164:167], v[228:231], v[148:151], v[164:167]
v_mfma_f32_16x16x32_bf16 v[160:163], v[232:235], v[136:139], v[160:163]
v_mfma_f32_16x16x32_bf16 v[164:167], v[232:235], v[152:155], v[164:167]
v_mfma_f32_16x16x32_bf16 v[160:163], v[236:239], v[140:143], v[160:163]
v_mfma_f32_16x16x32_bf16 v[164:167], v[236:239], v[156:159], v[164:167]
v_mfma_f32_16x16x32_bf16 v[168:171], v[240:243], v[128:131], 0
v_mfma_f32_16x16x32_bf16 v[172:175], v[240:243], v[144:147], 0
v_mfma_f32_16x16x32_bf16 v[168:171], v[244:247], v[132:135], v[168:171]
v_mfma_f32_16x16x32_bf16 v[172:175], v[244:247], v[148:151], v[172:175]
v_mfma_f32_16x16x32_bf16 v[168:171], v[248:251], v[136:139], v[168:171]
v_mfma_f32_16x16x32_bf16 v[172:175], v[248:251], v[152:155], v[172:175]
v_mfma_f32_16x16x32_bf16 v[168:171], v[252:255], v[140:143], v[168:171]
v_mfma_f32_16x16x32_bf16 v[172:175], v[252:255], v[156:159], v[172:175]
v_add_u32 v28, s43, v8
v_add_u32 v29, s43, v9
v_add_u32 v30, s43, v10
v_add_u32 v31, s43, v11
s_nop 7
ds_read_b128 v[224:227], v28 offset:0
ds_read_b128 v[228:231], v29 offset:0
ds_read_b128 v[232:235], v30 offset:0
ds_read_b128 v[236:239], v31 offset:0
ds_read_b128 v[240:243], v28 offset:4096
ds_read_b128 v[244:247], v29 offset:4096
ds_read_b128 v[248:251], v30 offset:4096
ds_read_b128 v[252:255], v31 offset:4096
s_waitcnt lgkmcnt(0)
v_mfma_f32_16x16x32_bf16 v[176:179], v[224:227], v[128:131], 0
v_mfma_f32_16x16x32_bf16 v[180:183], v[224:227], v[144:147], 0
v_mfma_f32_16x16x32_bf16 v[176:179], v[228:231], v[132:135], v[176:179]
v_mfma_f32_16x16x32_bf16 v[180:183], v[228:231], v[148:151], v[180:183]
v_mfma_f32_16x16x32_bf16 v[176:179], v[232:235], v[136:139], v[176:179]
v_mfma_f32_16x16x32_bf16 v[180:183], v[232:235], v[152:155], v[180:183]
v_mfma_f32_16x16x32_bf16 v[176:179], v[236:239], v[140:143], v[176:179]
v_mfma_f32_16x16x32_bf16 v[180:183], v[236:239], v[156:159], v[180:183]
v_mfma_f32_16x16x32_bf16 v[184:187], v[240:243], v[128:131], 0
v_mfma_f32_16x16x32_bf16 v[188:191], v[240:243], v[144:147], 0
v_mfma_f32_16x16x32_bf16 v[184:187], v[244:247], v[132:135], v[184:187]
v_mfma_f32_16x16x32_bf16 v[188:191], v[244:247], v[148:151], v[188:191]
v_mfma_f32_16x16x32_bf16 v[184:187], v[248:251], v[136:139], v[184:187]
v_mfma_f32_16x16x32_bf16 v[188:191], v[248:251], v[152:155], v[188:191]
v_mfma_f32_16x16x32_bf16 v[184:187], v[252:255], v[140:143], v[184:187]
v_mfma_f32_16x16x32_bf16 v[188:191], v[252:255], v[156:159], v[188:191]
s_nop 7
v_max3_f32 v27, v176, v177, v178
v_max3_f32 v27, v27, v179, v184
v_max3_f32 v27, v27, v185, v186
v_max3_f32 v27, v27, v187, -v32
v_max3_f32 v5, v180, v181, v182
v_max3_f32 v5, v5, v183, v188
v_max3_f32 v5, v5, v189, v190
v_max3_f32 v5, v5, v191, -v36
v_mov_b32 v2, v27
v_mov_b32 v6, v5
s_nop 1
v_permlane32_swap_b32 v27, v2
v_permlane32_swap_b32 v5, v6
v_max_f32 v27, v27, v2
v_max_f32 v5, v5, v6
v_mov_b32 v2, v27
v_mov_b32 v6, v5
s_nop 1
v_permlane16_swap_b32 v27, v2
v_permlane16_swap_b32 v5, v6
v_max_f32 v27, v27, v2
v_max_f32 v5, v5, v6
v_add_f32 v2, v32, v27
v_add_f32 v6, v36, v5
v_exp_f32 v2, -v2
v_exp_f32 v6, -v6
v_sub_f32 v32, 0, v27
v_sub_f32 v33, 0, v27
v_sub_f32 v34, 0, v27
v_sub_f32 v35, 0, v27
v_sub_f32 v36, 0, v5
v_sub_f32 v37, 0, v5
v_sub_f32 v38, 0, v5
v_sub_f32 v39, 0, v5
ds_bpermute_b32 v224, v24, v2 offset:0
ds_bpermute_b32 v225, v24, v2 offset:4
ds_bpermute_b32 v226, v24, v2 offset:8
ds_bpermute_b32 v227, v24, v2 offset:12
ds_bpermute_b32 v228, v24, v6 offset:0
ds_bpermute_b32 v229, v24, v6 offset:4
ds_bpermute_b32 v230, v24, v6 offset:8
ds_bpermute_b32 v231, v24, v6 offset:12
v_sub_f32 v160, v160, v27
v_sub_f32 v161, v161, v27
v_sub_f32 v162, v162, v27
v_sub_f32 v163, v163, v27
v_sub_f32 v164, v164, v5
v_sub_f32 v165, v165, v5
v_sub_f32 v166, v166, v5
v_sub_f32 v167, v167, v5
v_sub_f32 v168, v168, v27
v_sub_f32 v169, v169, v27
v_sub_f32 v170, v170, v27
v_sub_f32 v171, v171, v27
v_sub_f32 v172, v172, v5
v_sub_f32 v173, v173, v5
v_sub_f32 v174, v174, v5
v_sub_f32 v175, v175, v5
v_sub_f32 v176, v176, v27
v_sub_f32 v177, v177, v27
v_sub_f32 v178, v178, v27
v_sub_f32 v179, v179, v27
v_sub_f32 v180, v180, v5
v_sub_f32 v181, v181, v5
v_sub_f32 v182, v182, v5
v_sub_f32 v183, v183, v5
v_sub_f32 v184, v184, v27
v_sub_f32 v185, v185, v27
v_sub_f32 v186, v186, v27
v_sub_f32 v187, v187, v27
v_sub_f32 v188, v188, v5
v_sub_f32 v189, v189, v5
v_sub_f32 v190, v190, v5
v_sub_f32 v191, v191, v5
v_exp_f32 v176, v176
v_exp_f32 v177, v177
v_exp_f32 v178, v178
v_exp_f32 v179, v179
v_exp_f32 v180, v180
v_exp_f32 v181, v181
v_exp_f32 v182, v182
v_exp_f32 v183, v183
v_exp_f32 v184, v184
v_exp_f32 v185, v185
v_exp_f32 v186, v186
v_exp_f32 v187, v187
v_exp_f32 v188, v188
v_exp_f32 v189, v189
v_exp_f32 v190, v190
v_exp_f32 v191, v191
v_mul_f32 v25, v2, v25
v_mul_f32 v26, v6, v26
v_cvt_pk_bf16_f32 v56, v176, v177
v_cvt_pk_bf16_f32 v57, v178, v179
v_cvt_pk_bf16_f32 v60, v180, v181
v_cvt_pk_bf16_f32 v61, v182, v183
v_cvt_pk_bf16_f32 v58, v184, v185
v_cvt_pk_bf16_f32 v59, v186, v187
v_cvt_pk_bf16_f32 v62, v188, v189
v_cvt_pk_bf16_f32 v63, v190, v191
s_nop 0
s_waitcnt lgkmcnt(0)
v_mfma_f32_16x16x32_bf16 v[40:43], v[20:23], v[56:59], 0
v_mfma_f32_16x16x32_bf16 v[44:47], v[20:23], v[60:63], 0
v_mul_f32 v64, v224, v64
v_mul_f32 v65, v225, v65
v_mul_f32 v66, v226, v66
v_mul_f32 v67, v227, v67
v_mul_f32 v68, v224, v68
v_mul_f32 v69, v225, v69
v_mul_f32 v70, v226, v70
v_mul_f32 v71, v227, v71
v_mul_f32 v72, v224, v72
v_mul_f32 v73, v225, v73
v_mul_f32 v74, v226, v74
v_mul_f32 v75, v227, v75
v_mul_f32 v76, v224, v76
v_mul_f32 v77, v225, v77
v_mul_f32 v78, v226, v78
v_mul_f32 v79, v227, v79
v_mul_f32 v80, v228, v80
v_mul_f32 v81, v229, v81
v_mul_f32 v82, v230, v82
v_mul_f32 v83, v231, v83
v_mul_f32 v84, v228, v84
v_mul_f32 v85, v229, v85
v_mul_f32 v86, v230, v86
v_mul_f32 v87, v231, v87
v_mul_f32 v88, v228, v88
v_mul_f32 v89, v229, v89
v_mul_f32 v90, v230, v90
v_mul_f32 v91, v231, v91
v_mul_f32 v92, v228, v92
v_mul_f32 v93, v229, v93
v_mul_f32 v94, v230, v94
v_mul_f32 v95, v231, v95
v_mul_f32 v96, v224, v96
v_mul_f32 v97, v225, v97
v_mul_f32 v98, v226, v98
v_mul_f32 v99, v227, v99
v_mul_f32 v100, v224, v100
v_mul_f32 v101, v225, v101
v_mul_f32 v102, v226, v102
v_mul_f32 v103, v227, v103
v_mul_f32 v104, v224, v104
v_mul_f32 v105, v225, v105
v_mul_f32 v106, v226, v106
v_mul_f32 v107, v227, v107
v_mul_f32 v108, v224, v108
v_mul_f32 v109, v225, v109
v_mul_f32 v110, v226, v110
v_mul_f32 v111, v227, v111
v_mul_f32 v112, v228, v112
v_mul_f32 v113, v229, v113
v_mul_f32 v114, v230, v114
v_mul_f32 v115, v231, v115
v_mul_f32 v116, v228, v116
v_mul_f32 v117, v229, v117
v_mul_f32 v118, v230, v118
v_mul_f32 v119, v231, v119
v_mul_f32 v120, v228, v120
v_mul_f32 v121, v229, v121
v_mul_f32 v122, v230, v122
v_mul_f32 v123, v231, v123
v_mul_f32 v124, v228, v124
v_mul_f32 v125, v229, v125
v_mul_f32 v126, v230, v126
v_mul_f32 v127, v231, v127
s_setpc_b64 s[50:51]
.section .rodata,"a"
.p2align 6
.amdhsa_kernel standalone__gqa_softmax__sampling_kernel
  .amdhsa_next_free_vgpr 256
  .amdhsa_next_free_sgpr 96
  .amdhsa_accum_offset 256
  .amdhsa_group_segment_fixed_size 0
  .amdhsa_kernarg_size 48
  .amdhsa_user_sgpr_count 2
  .amdhsa_user_sgpr_kernarg_segment_ptr 1
  .amdhsa_system_sgpr_workgroup_id_x 1
  .amdhsa_float_denorm_mode_32 3
.end_amdhsa_kernel
```
